```python
import torch

def _softmax(x, axis=-1):
    return torch.softmax(x, dim=axis)
def _gelu(x):
    return torch.nn.functional.gelu(x, approximate="tanh")
def _silu(x):
    return torch.nn.functional.silu(x)
def _sigmoid(x):
    return torch.sigmoid(x)
def _layernorm(x, axis=-1, eps=1e-5):
    m = x.mean(dim=axis, keepdim=True)
    v = x.var(dim=axis, keepdim=True, unbiased=False)
    return (x - m) / torch.sqrt(v + eps)
def _scatter_add(tgt, idx, src, axis=0):
    return tgt.clone().index_add_(axis, idx, src)
def _segment_sum(src, seg, n):
    out = torch.zeros((n,) + src.shape[1:], dtype=src.dtype)
    return out.index_add_(0, seg, src)
def _pad(x, pw):
    flat = tuple(v for pair in reversed(pw) for v in pair)
    return torch.nn.functional.pad(x, flat)

kernel_name = 'parallel_sum__spectral_fnet__dense_activation_relu__prompt'

def setup_inputs():

    _w = (lambda a: (lambda t: t.to(torch.bfloat16) if t.is_floating_point() else t)(torch.as_tensor(a)))
    def _A_setup():
        B, S, D = 1, 2048, 512
        ns = torch.arange(S)[:, None] * torch.arange(S)[None, :]
        nd = torch.arange(D)[:, None] * torch.arange(D)[None, :]
        Ws_re = torch.cos(-2.0 * torch.pi * ns / S).to(float)
        Ws_im = torch.sin(-2.0 * torch.pi * ns / S).to(float)
        Wd_re = torch.cos(-2.0 * torch.pi * nd / D).to(float)
        Wd_im = torch.sin(-2.0 * torch.pi * nd / D).to(float)
        return {
            "x": _w((lambda *s: torch.randn(*s, dtype=torch.bfloat16) * 0.05)(B, S, D)),
            "dft_seq_re": _w(Ws_re),
            "dft_seq_im": _w(Ws_im),
            "dft_hid_re": _w(Wd_re),
            "dft_hid_im": _w(Wd_im),
        }
    _A_in = _A_setup()

    def _B_setup():
        B, S, D, Dff = 1, 2048, 512, 1792
        return {
            "x": _w((lambda *s: torch.randn(*s, dtype=torch.bfloat16) * 0.05)(B, S, D)),
            "w1": _w((lambda *s: torch.randn(*s, dtype=torch.bfloat16) * 0.4)(D, Dff)),
            "w2": _w((lambda *s: torch.randn(*s, dtype=torch.bfloat16) * 0.4)(Dff, D)),
        }
    _B_in = _B_setup()

    return {
        "A_x": _A_in["x"],
        "A_dft_seq_re": _A_in["dft_seq_re"],
        "A_dft_seq_im": _A_in["dft_seq_im"],
        "A_dft_hid_re": _A_in["dft_hid_re"],
        "A_dft_hid_im": _A_in["dft_hid_im"],
        "B_x": _B_in["x"],
        "B_w1": _B_in["w1"],
        "B_w2": _B_in["w2"],
    }

def reference(A_x, A_dft_seq_re, A_dft_seq_im, A_dft_hid_re, A_dft_hid_im, B_x, B_w1, B_w2):
    def _A_ref(x, dft_seq_re, dft_seq_im, dft_hid_re, dft_hid_im):
        a = torch.einsum("bsd,ed->bse", x, dft_hid_re)
        b = torch.einsum("bsd,ed->bse", x, dft_hid_im)
        y = torch.einsum("ts,bse->bte", dft_seq_re, a) - torch.einsum("ts,bse->bte", dft_seq_im, b)
        return y

    def _B_ref(x, w1, w2):
        h = torch.einsum("bsd,df->bsf", x, w1)
        zero = torch.zeros_like(h)
        h = torch.maximum(h, zero)
        return torch.einsum("bsf,fd->bsd", h, w2)

    x = A_x
    xn = _layernorm(x, axis=-1)
    return x + _A_ref(xn, A_dft_seq_re, A_dft_seq_im, A_dft_hid_re, A_dft_hid_im) + _B_ref(xn, B_w1, B_w2)
```

```asm
; @launch kernel=fused_kernel grid=(256,1,1) block=(512,1,1) lds=146432
.amdgcn_target "amdgcn-amd-amdhsa--gfx950"
.text
.globl fused_kernel
.p2align 8
.type fused_kernel,@function
fused_kernel:
    s_cmpk_ge_u32 s2, 256
    s_cbranch_scc1 K2_END
    s_load_dwordx16 s[16:31], s[0:1], 0
    s_load_dwordx4 s[32:35], s[0:1], 64
    s_load_dwordx2 s[36:37], s[0:1], 80
    v_lshrrev_b32 v1, 6, v0
    s_nop 0
    v_readfirstlane_b32 s60, v1
    s_and_b32 s87, s60, 3
    s_getpc_b64 s[92:93]
CPF_k1:
    v_lshlrev_b32 v252, 7, v0
    v_min_u32 v252, CODE_END-CPF_k1-4, v252
    v_add_co_u32 v252, vcc, s92, v252
    v_mov_b32 v253, s93
    v_addc_co_u32 v253, vcc, 0, v253, vcc
    global_load_dword v254, v[252:253], off
    s_and_b32 s4, s2, 7
    s_lshr_b32 s5, s2, 3
    s_and_b32 s6, s5, 1
    s_lshl_b32 s4, s4, 1
    s_add_u32 s6, s4, s6
    s_lshr_b32 s7, s5, 2
    s_waitcnt lgkmcnt(0)
    s_bitcmp1_b32 s5, 1
    s_cbranch_scc0 K1_AB
    s_mov_b32 s40, s28
    s_mov_b32 s41, s29
    s_mov_b32 s42, 0x1c0000
    s_mov_b32 s43, 0x00020000
    s_mov_b32 s44, s16
    s_mov_b32 s45, s17
    s_mov_b32 s46, 0x200000
    s_mov_b32 s47, 0x00020000
    s_mul_i32 s61, s7, 448
    s_lshl_b32 s62, s6, 17
    s_mov_b32 s11, 0
    s_cmp_lt_u32 s60, 4
    s_cbranch_scc1 K1_H_CMP
    s_mov_b32 s12, 0
    v_and_b32 v2, 63, v0
    v_lshrrev_b32 v3, 3, v2
    v_and_b32 v4, 7, v2
    v_xor_b32 v4, v4, v3
    v_lshlrev_b32 v4, 4, v4
    s_mul_i32 s63, s87, 448
    v_add_u32 v24, s63, v2
    v_mov_b32 v26, 0x924924a
    v_mul_hi_u32 v25, v24, v26
    v_mul_u32_u24 v26, 28, v25
    v_sub_u32 v24, v24, v26
    v_lshrrev_b32 v26, 2, v25
    v_and_b32 v26, 2, v26
    v_xor_b32 v24, v24, v26
    v_mul_u32_u24 v25, 3584, v25
    v_lshl_add_u32 v24, v24, 4, v25
    v_add_u32 v24, s61, v24
    v_mov_b32 v8, v24
    v_add_u32 v24, s63, v2
    v_add_u32 v24, 64, v24
    v_mov_b32 v26, 0x924924a
    v_mul_hi_u32 v25, v24, v26
    v_mul_u32_u24 v26, 28, v25
    v_sub_u32 v24, v24, v26
    v_lshrrev_b32 v26, 2, v25
    v_and_b32 v26, 2, v26
    v_xor_b32 v24, v24, v26
    v_mul_u32_u24 v25, 3584, v25
    v_lshl_add_u32 v24, v24, 4, v25
    v_add_u32 v24, s61, v24
    v_subrev_u32 v9, 1024, v24
    v_add_u32 v24, s63, v2
    v_add_u32 v24, 128, v24
    v_mov_b32 v26, 0x924924a
    v_mul_hi_u32 v25, v24, v26
    v_mul_u32_u24 v26, 28, v25
    v_sub_u32 v24, v24, v26
    v_lshrrev_b32 v26, 2, v25
    v_and_b32 v26, 2, v26
    v_xor_b32 v24, v24, v26
    v_mul_u32_u24 v25, 3584, v25
    v_lshl_add_u32 v24, v24, 4, v25
    v_add_u32 v24, s61, v24
    v_subrev_u32 v10, 2048, v24
    v_add_u32 v24, s63, v2
    v_add_u32 v24, 192, v24
    v_mov_b32 v26, 0x924924a
    v_mul_hi_u32 v25, v24, v26
    v_mul_u32_u24 v26, 28, v25
    v_sub_u32 v24, v24, v26
    v_lshrrev_b32 v26, 2, v25
    v_and_b32 v26, 2, v26
    v_xor_b32 v24, v24, v26
    v_mul_u32_u24 v25, 3584, v25
    v_lshl_add_u32 v24, v24, 4, v25
    v_add_u32 v24, s61, v24
    v_subrev_u32 v11, 3072, v24
    v_add_u32 v24, s63, v2
    v_add_u32 v24, 256, v24
    v_mov_b32 v26, 0x924924a
    v_mul_hi_u32 v25, v24, v26
    v_mul_u32_u24 v26, 28, v25
    v_sub_u32 v24, v24, v26
    v_lshrrev_b32 v26, 2, v25
    v_and_b32 v26, 2, v26
    v_xor_b32 v24, v24, v26
    v_mul_u32_u24 v25, 3584, v25
    v_lshl_add_u32 v24, v24, 4, v25
    v_add_u32 v24, s61, v24
    v_mov_b32 v12, v24
    v_add_u32 v24, s63, v2
    v_add_u32 v24, 320, v24
    v_mov_b32 v26, 0x924924a
    v_mul_hi_u32 v25, v24, v26
    v_mul_u32_u24 v26, 28, v25
    v_sub_u32 v24, v24, v26
    v_lshrrev_b32 v26, 2, v25
    v_and_b32 v26, 2, v26
    v_xor_b32 v24, v24, v26
    v_mul_u32_u24 v25, 3584, v25
    v_lshl_add_u32 v24, v24, 4, v25
    v_add_u32 v24, s61, v24
    v_subrev_u32 v13, 1024, v24
    v_add_u32 v24, s63, v2
    v_add_u32 v24, 384, v24
    v_mov_b32 v26, 0x924924a
    v_mul_hi_u32 v25, v24, v26
    v_mul_u32_u24 v26, 28, v25
    v_sub_u32 v24, v24, v26
    v_lshrrev_b32 v26, 2, v25
    v_and_b32 v26, 2, v26
    v_xor_b32 v24, v24, v26
    v_mul_u32_u24 v25, 3584, v25
    v_lshl_add_u32 v24, v24, 4, v25
    v_add_u32 v24, s61, v24
    v_subrev_u32 v14, 2048, v24
    s_lshl_b32 s63, s87, 5
    v_add_u32 v5, s63, v3
    s_mov_b32 s63, 1024
    v_mul_lo_u32 v5, v5, s63
    v_add_u32 v5, v5, v4
    v_add_u32 v5, s62, v5
    v_mov_b32 v15, v5
    v_add_u32 v16, 0x1c00, v5
    v_add_u32 v17, 0x3800, v5
    v_add_u32 v18, 0x5400, v5
    s_mul_i32 s64, s87, 7168
    s_lshl_b32 s65, s87, 12
    s_add_u32 s65, s65, 28672
    v_lshlrev_b32 v48, 4, v2
    s_lshl_b32 s63, s87, 12
    s_add_u32 s63, s63, 28672
    v_add_u32 v48, s63, v48
    v_mov_b32 v40, 0
    v_mov_b32 v41, 0
    v_mov_b32 v42, 0
    v_mov_b32 v43, 0
    v_mov_b32 v44, 0
    v_mov_b32 v45, 0
    v_mov_b32 v46, 0
    v_mov_b32 v47, 0
    s_mov_b32 s86, 0
    s_mov_b32 s88, 0x3f803f80
    s_mov_b32 s84, 0
    s_add_u32 m0, s84, s64
    s_nop 0
    buffer_load_dwordx4 v8, s[40:43], s12 offen offset:0 lds
    buffer_load_dwordx4 v9, s[40:43], s12 offen offset:1024 lds
    buffer_load_dwordx4 v10, s[40:43], s12 offen offset:2048 lds
    buffer_load_dwordx4 v11, s[40:43], s12 offen offset:3072 lds
    s_add_u32 m0, m0, 4096
    s_nop 0
    buffer_load_dwordx4 v12, s[40:43], s12 offen offset:0 lds
    buffer_load_dwordx4 v13, s[40:43], s12 offen offset:1024 lds
    buffer_load_dwordx4 v14, s[40:43], s12 offen offset:2048 lds
    s_add_u32 m0, s84, s65
    s_nop 0
    buffer_load_dwordx4 v15, s[44:47], s11 offen offset:0 lds
    buffer_load_dwordx4 v16, s[44:47], s11 offen offset:1024 lds
    buffer_load_dwordx4 v17, s[44:47], s11 offen offset:2048 lds
    buffer_load_dwordx4 v18, s[44:47], s11 offen offset:3072 lds
    s_add_u32 s11, s11, 128
    s_add_u32 s12, s12, 229376
    s_add_u32 s84, s84, 45056
    s_cmp_eq_u32 s84, 135168
    s_cselect_b32 s84, 0, s84
    s_add_u32 m0, s84, s64
    s_nop 0
    buffer_load_dwordx4 v8, s[40:43], s12 offen offset:0 lds
    buffer_load_dwordx4 v9, s[40:43], s12 offen offset:1024 lds
    buffer_load_dwordx4 v10, s[40:43], s12 offen offset:2048 lds
    buffer_load_dwordx4 v11, s[40:43], s12 offen offset:3072 lds
    s_add_u32 m0, m0, 4096
    s_nop 0
    buffer_load_dwordx4 v12, s[40:43], s12 offen offset:0 lds
    buffer_load_dwordx4 v13, s[40:43], s12 offen offset:1024 lds
    buffer_load_dwordx4 v14, s[40:43], s12 offen offset:2048 lds
    s_add_u32 m0, s84, s65
    s_nop 0
    buffer_load_dwordx4 v15, s[44:47], s11 offen offset:0 lds
    buffer_load_dwordx4 v16, s[44:47], s11 offen offset:1024 lds
    buffer_load_dwordx4 v17, s[44:47], s11 offen offset:2048 lds
    buffer_load_dwordx4 v18, s[44:47], s11 offen offset:3072 lds
    s_add_u32 s11, s11, 128
    s_add_u32 s12, s12, 229376
    s_add_u32 s84, s84, 45056
    s_cmp_eq_u32 s84, 135168
    s_cselect_b32 s84, 0, s84
    s_add_u32 m0, s84, s64
    s_nop 0
    buffer_load_dwordx4 v8, s[40:43], s12 offen offset:0 lds
    buffer_load_dwordx4 v9, s[40:43], s12 offen offset:1024 lds
    buffer_load_dwordx4 v10, s[40:43], s12 offen offset:2048 lds
    buffer_load_dwordx4 v11, s[40:43], s12 offen offset:3072 lds
    s_add_u32 m0, m0, 4096
    s_nop 0
    buffer_load_dwordx4 v12, s[40:43], s12 offen offset:0 lds
    buffer_load_dwordx4 v13, s[40:43], s12 offen offset:1024 lds
    buffer_load_dwordx4 v14, s[40:43], s12 offen offset:2048 lds
    s_add_u32 m0, s84, s65
    s_nop 0
    buffer_load_dwordx4 v15, s[44:47], s11 offen offset:0 lds
    buffer_load_dwordx4 v16, s[44:47], s11 offen offset:1024 lds
    buffer_load_dwordx4 v17, s[44:47], s11 offen offset:2048 lds
    buffer_load_dwordx4 v18, s[44:47], s11 offen offset:3072 lds
    s_add_u32 s11, s11, 128
    s_add_u32 s12, s12, 229376
    s_add_u32 s84, s84, 45056
    s_cmp_eq_u32 s84, 135168
    s_cselect_b32 s84, 0, s84
    s_waitcnt vmcnt(22)
    s_barrier
    s_mov_b32 s85, 0
LLOOP_h:
    v_add_u32 v49, s86, v48
    ds_read_b128 v[24:27], v49 offset:0
    ds_read_b128 v[28:31], v49 offset:1024
    s_waitcnt lgkmcnt(1)
    v_dot2_f32_bf16 v40, v24, s88, v40
    v_dot2_f32_bf16 v44, v24, v24, v44
    v_dot2_f32_bf16 v40, v25, s88, v40
    v_dot2_f32_bf16 v44, v25, v25, v44
    v_dot2_f32_bf16 v40, v26, s88, v40
    v_dot2_f32_bf16 v44, v26, v26, v44
    v_dot2_f32_bf16 v40, v27, s88, v40
    v_dot2_f32_bf16 v44, v27, v27, v44
    s_waitcnt lgkmcnt(0)
    v_dot2_f32_bf16 v41, v28, s88, v41
    v_dot2_f32_bf16 v45, v28, v28, v45
    v_dot2_f32_bf16 v41, v29, s88, v41
    v_dot2_f32_bf16 v45, v29, v29, v45
    v_dot2_f32_bf16 v41, v30, s88, v41
    v_dot2_f32_bf16 v45, v30, v30, v45
    v_dot2_f32_bf16 v41, v31, s88, v41
    v_dot2_f32_bf16 v45, v31, v31, v45
    s_waitcnt vmcnt(11)
    s_barrier
    v_add_u32 v49, s86, v48
    ds_read_b128 v[32:35], v49 offset:2048
    ds_read_b128 v[36:39], v49 offset:3072
    s_waitcnt lgkmcnt(1)
    v_dot2_f32_bf16 v42, v32, s88, v42
    v_dot2_f32_bf16 v46, v32, v32, v46
    v_dot2_f32_bf16 v42, v33, s88, v42
    v_dot2_f32_bf16 v46, v33, v33, v46
    v_dot2_f32_bf16 v42, v34, s88, v42
    v_dot2_f32_bf16 v46, v34, v34, v46
    v_dot2_f32_bf16 v42, v35, s88, v42
    v_dot2_f32_bf16 v46, v35, v35, v46
    s_waitcnt lgkmcnt(0)
    v_dot2_f32_bf16 v43, v36, s88, v43
    v_dot2_f32_bf16 v47, v36, v36, v47
    v_dot2_f32_bf16 v43, v37, s88, v43
    v_dot2_f32_bf16 v47, v37, v37, v47
    v_dot2_f32_bf16 v43, v38, s88, v43
    v_dot2_f32_bf16 v47, v38, v38, v47
    v_dot2_f32_bf16 v43, v39, s88, v43
    v_dot2_f32_bf16 v47, v39, v39, v47
    s_add_u32 s86, s86, 45056
    s_cmp_eq_u32 s86, 135168
    s_cselect_b32 s86, 0, s86
    s_barrier
    s_add_u32 m0, s84, s64
    s_nop 0
    buffer_load_dwordx4 v8, s[40:43], s12 offen offset:0 lds
    buffer_load_dwordx4 v9, s[40:43], s12 offen offset:1024 lds
    buffer_load_dwordx4 v10, s[40:43], s12 offen offset:2048 lds
    buffer_load_dwordx4 v11, s[40:43], s12 offen offset:3072 lds
    s_add_u32 m0, m0, 4096
    s_nop 0
    buffer_load_dwordx4 v12, s[40:43], s12 offen offset:0 lds
    buffer_load_dwordx4 v13, s[40:43], s12 offen offset:1024 lds
    buffer_load_dwordx4 v14, s[40:43], s12 offen offset:2048 lds
    s_add_u32 m0, s84, s65
    s_nop 0
    buffer_load_dwordx4 v15, s[44:47], s11 offen offset:0 lds
    buffer_load_dwordx4 v16, s[44:47], s11 offen offset:1024 lds
    buffer_load_dwordx4 v17, s[44:47], s11 offen offset:2048 lds
    buffer_load_dwordx4 v18, s[44:47], s11 offen offset:3072 lds
    s_add_u32 s11, s11, 128
    s_add_u32 s12, s12, 229376
    s_add_u32 s84, s84, 45056
    s_cmp_eq_u32 s84, 135168
    s_cselect_b32 s84, 0, s84
    s_add_u32 s85, s85, 1
    s_cmp_lt_u32 s85, 5
    s_cbranch_scc1 LLOOP_h
    v_add_u32 v49, s86, v48
    ds_read_b128 v[24:27], v49 offset:0
    ds_read_b128 v[28:31], v49 offset:1024
    s_waitcnt lgkmcnt(1)
    v_dot2_f32_bf16 v40, v24, s88, v40
    v_dot2_f32_bf16 v44, v24, v24, v44
    v_dot2_f32_bf16 v40, v25, s88, v40
    v_dot2_f32_bf16 v44, v25, v25, v44
    v_dot2_f32_bf16 v40, v26, s88, v40
    v_dot2_f32_bf16 v44, v26, v26, v44
    v_dot2_f32_bf16 v40, v27, s88, v40
    v_dot2_f32_bf16 v44, v27, v27, v44
    s_waitcnt lgkmcnt(0)
    v_dot2_f32_bf16 v41, v28, s88, v41
    v_dot2_f32_bf16 v45, v28, v28, v45
    v_dot2_f32_bf16 v41, v29, s88, v41
    v_dot2_f32_bf16 v45, v29, v29, v45
    v_dot2_f32_bf16 v41, v30, s88, v41
    v_dot2_f32_bf16 v45, v30, v30, v45
    v_dot2_f32_bf16 v41, v31, s88, v41
    v_dot2_f32_bf16 v45, v31, v31, v45
    s_waitcnt vmcnt(11)
    s_barrier
    v_add_u32 v49, s86, v48
    ds_read_b128 v[32:35], v49 offset:2048
    ds_read_b128 v[36:39], v49 offset:3072
    s_waitcnt lgkmcnt(1)
    v_dot2_f32_bf16 v42, v32, s88, v42
    v_dot2_f32_bf16 v46, v32, v32, v46
    v_dot2_f32_bf16 v42, v33, s88, v42
    v_dot2_f32_bf16 v46, v33, v33, v46
    v_dot2_f32_bf16 v42, v34, s88, v42
    v_dot2_f32_bf16 v46, v34, v34, v46
    v_dot2_f32_bf16 v42, v35, s88, v42
    v_dot2_f32_bf16 v46, v35, v35, v46
    s_waitcnt lgkmcnt(0)
    v_dot2_f32_bf16 v43, v36, s88, v43
    v_dot2_f32_bf16 v47, v36, v36, v47
    v_dot2_f32_bf16 v43, v37, s88, v43
    v_dot2_f32_bf16 v47, v37, v37, v47
    v_dot2_f32_bf16 v43, v38, s88, v43
    v_dot2_f32_bf16 v47, v38, v38, v47
    v_dot2_f32_bf16 v43, v39, s88, v43
    v_dot2_f32_bf16 v47, v39, v39, v47
    s_add_u32 s86, s86, 45056
    s_cmp_eq_u32 s86, 135168
    s_cselect_b32 s86, 0, s86
    s_barrier
    v_add_u32 v49, s86, v48
    ds_read_b128 v[24:27], v49 offset:0
    ds_read_b128 v[28:31], v49 offset:1024
    s_waitcnt lgkmcnt(1)
    v_dot2_f32_bf16 v40, v24, s88, v40
    v_dot2_f32_bf16 v44, v24, v24, v44
    v_dot2_f32_bf16 v40, v25, s88, v40
    v_dot2_f32_bf16 v44, v25, v25, v44
    v_dot2_f32_bf16 v40, v26, s88, v40
    v_dot2_f32_bf16 v44, v26, v26, v44
    v_dot2_f32_bf16 v40, v27, s88, v40
    v_dot2_f32_bf16 v44, v27, v27, v44
    s_waitcnt lgkmcnt(0)
    v_dot2_f32_bf16 v41, v28, s88, v41
    v_dot2_f32_bf16 v45, v28, v28, v45
    v_dot2_f32_bf16 v41, v29, s88, v41
    v_dot2_f32_bf16 v45, v29, v29, v45
    v_dot2_f32_bf16 v41, v30, s88, v41
    v_dot2_f32_bf16 v45, v30, v30, v45
    v_dot2_f32_bf16 v41, v31, s88, v41
    v_dot2_f32_bf16 v45, v31, v31, v45
    s_waitcnt vmcnt(0)
    s_barrier
    v_add_u32 v49, s86, v48
    ds_read_b128 v[32:35], v49 offset:2048
    ds_read_b128 v[36:39], v49 offset:3072
    s_waitcnt lgkmcnt(1)
    v_dot2_f32_bf16 v42, v32, s88, v42
    v_dot2_f32_bf16 v46, v32, v32, v46
    v_dot2_f32_bf16 v42, v33, s88, v42
    v_dot2_f32_bf16 v46, v33, v33, v46
    v_dot2_f32_bf16 v42, v34, s88, v42
    v_dot2_f32_bf16 v46, v34, v34, v46
    v_dot2_f32_bf16 v42, v35, s88, v42
    v_dot2_f32_bf16 v46, v35, v35, v46
    s_waitcnt lgkmcnt(0)
    v_dot2_f32_bf16 v43, v36, s88, v43
    v_dot2_f32_bf16 v47, v36, v36, v47
    v_dot2_f32_bf16 v43, v37, s88, v43
    v_dot2_f32_bf16 v47, v37, v37, v47
    v_dot2_f32_bf16 v43, v38, s88, v43
    v_dot2_f32_bf16 v47, v38, v38, v47
    v_dot2_f32_bf16 v43, v39, s88, v43
    v_dot2_f32_bf16 v47, v39, v39, v47
    s_add_u32 s86, s86, 45056
    s_cmp_eq_u32 s86, 135168
    s_cselect_b32 s86, 0, s86
    s_barrier
    v_add_u32 v49, s86, v48
    ds_read_b128 v[24:27], v49 offset:0
    ds_read_b128 v[28:31], v49 offset:1024
    s_waitcnt lgkmcnt(1)
    v_dot2_f32_bf16 v40, v24, s88, v40
    v_dot2_f32_bf16 v44, v24, v24, v44
    v_dot2_f32_bf16 v40, v25, s88, v40
    v_dot2_f32_bf16 v44, v25, v25, v44
    v_dot2_f32_bf16 v40, v26, s88, v40
    v_dot2_f32_bf16 v44, v26, v26, v44
    v_dot2_f32_bf16 v40, v27, s88, v40
    v_dot2_f32_bf16 v44, v27, v27, v44
    s_waitcnt lgkmcnt(0)
    v_dot2_f32_bf16 v41, v28, s88, v41
    v_dot2_f32_bf16 v45, v28, v28, v45
    v_dot2_f32_bf16 v41, v29, s88, v41
    v_dot2_f32_bf16 v45, v29, v29, v45
    v_dot2_f32_bf16 v41, v30, s88, v41
    v_dot2_f32_bf16 v45, v30, v30, v45
    v_dot2_f32_bf16 v41, v31, s88, v41
    v_dot2_f32_bf16 v45, v31, v31, v45
    s_waitcnt vmcnt(0)
    s_barrier
    v_add_u32 v49, s86, v48
    ds_read_b128 v[32:35], v49 offset:2048
    ds_read_b128 v[36:39], v49 offset:3072
    s_waitcnt lgkmcnt(1)
    v_dot2_f32_bf16 v42, v32, s88, v42
    v_dot2_f32_bf16 v46, v32, v32, v46
    v_dot2_f32_bf16 v42, v33, s88, v42
    v_dot2_f32_bf16 v46, v33, v33, v46
    v_dot2_f32_bf16 v42, v34, s88, v42
    v_dot2_f32_bf16 v46, v34, v34, v46
    v_dot2_f32_bf16 v42, v35, s88, v42
    v_dot2_f32_bf16 v46, v35, v35, v46
    s_waitcnt lgkmcnt(0)
    v_dot2_f32_bf16 v43, v36, s88, v43
    v_dot2_f32_bf16 v47, v36, v36, v47
    v_dot2_f32_bf16 v43, v37, s88, v43
    v_dot2_f32_bf16 v47, v37, v37, v47
    v_dot2_f32_bf16 v43, v38, s88, v43
    v_dot2_f32_bf16 v47, v38, v38, v47
    v_dot2_f32_bf16 v43, v39, s88, v43
    v_dot2_f32_bf16 v47, v39, v39, v47
    s_add_u32 s86, s86, 45056
    s_cmp_eq_u32 s86, 135168
    s_cselect_b32 s86, 0, s86
    s_barrier
    v_add_f32_dpp v24, v40, v40 quad_perm:[1,0,3,2] row_mask:0xf bank_mask:0xf
    v_add_f32_dpp v25, v41, v41 quad_perm:[1,0,3,2] row_mask:0xf bank_mask:0xf
    v_add_f32_dpp v26, v42, v42 quad_perm:[1,0,3,2] row_mask:0xf bank_mask:0xf
    v_add_f32_dpp v27, v43, v43 quad_perm:[1,0,3,2] row_mask:0xf bank_mask:0xf
    v_add_f32_dpp v28, v44, v44 quad_perm:[1,0,3,2] row_mask:0xf bank_mask:0xf
    v_add_f32_dpp v29, v45, v45 quad_perm:[1,0,3,2] row_mask:0xf bank_mask:0xf
    v_add_f32_dpp v30, v46, v46 quad_perm:[1,0,3,2] row_mask:0xf bank_mask:0xf
    v_add_f32_dpp v31, v47, v47 quad_perm:[1,0,3,2] row_mask:0xf bank_mask:0xf
    s_nop 1
    v_mov_b32 v40, v24
    v_mov_b32 v41, v25
    v_mov_b32 v42, v26
    v_mov_b32 v43, v27
    v_mov_b32 v44, v28
    v_mov_b32 v45, v29
    v_mov_b32 v46, v30
    v_mov_b32 v47, v31
    s_nop 1
    v_add_f32_dpp v24, v40, v40 quad_perm:[2,3,0,1] row_mask:0xf bank_mask:0xf
    v_add_f32_dpp v25, v41, v41 quad_perm:[2,3,0,1] row_mask:0xf bank_mask:0xf
    v_add_f32_dpp v26, v42, v42 quad_perm:[2,3,0,1] row_mask:0xf bank_mask:0xf
    v_add_f32_dpp v27, v43, v43 quad_perm:[2,3,0,1] row_mask:0xf bank_mask:0xf
    v_add_f32_dpp v28, v44, v44 quad_perm:[2,3,0,1] row_mask:0xf bank_mask:0xf
    v_add_f32_dpp v29, v45, v45 quad_perm:[2,3,0,1] row_mask:0xf bank_mask:0xf
    v_add_f32_dpp v30, v46, v46 quad_perm:[2,3,0,1] row_mask:0xf bank_mask:0xf
    v_add_f32_dpp v31, v47, v47 quad_perm:[2,3,0,1] row_mask:0xf bank_mask:0xf
    s_nop 1
    v_mov_b32 v40, v24
    v_mov_b32 v41, v25
    v_mov_b32 v42, v26
    v_mov_b32 v43, v27
    v_mov_b32 v44, v28
    v_mov_b32 v45, v29
    v_mov_b32 v46, v30
    v_mov_b32 v47, v31
    s_nop 1
    v_add_f32_dpp v24, v40, v40 row_half_mirror row_mask:0xf bank_mask:0xf
    v_add_f32_dpp v25, v41, v41 row_half_mirror row_mask:0xf bank_mask:0xf
    v_add_f32_dpp v26, v42, v42 row_half_mirror row_mask:0xf bank_mask:0xf
    v_add_f32_dpp v27, v43, v43 row_half_mirror row_mask:0xf bank_mask:0xf
    v_add_f32_dpp v28, v44, v44 row_half_mirror row_mask:0xf bank_mask:0xf
    v_add_f32_dpp v29, v45, v45 row_half_mirror row_mask:0xf bank_mask:0xf
    v_add_f32_dpp v30, v46, v46 row_half_mirror row_mask:0xf bank_mask:0xf
    v_add_f32_dpp v31, v47, v47 row_half_mirror row_mask:0xf bank_mask:0xf
    s_nop 1
    v_mov_b32 v40, v24
    v_mov_b32 v41, v25
    v_mov_b32 v42, v26
    v_mov_b32 v43, v27
    v_mov_b32 v44, v28
    v_mov_b32 v45, v29
    v_mov_b32 v46, v30
    v_mov_b32 v47, v31
    s_nop 1
    v_lshrrev_b32 v49, 3, v2
    s_lshl_b32 s63, s87, 5
    v_add_u32 v49, s63, v49
    v_lshlrev_b32 v49, 2, v49
    v_add_u32 v49, 135168, v49
    v_mul_f32 v40, 0x3b000000, v40
    v_mul_f32 v44, 0x3b000000, v44
    v_fma_f32 v44, -v40, v40, v44
    v_max_f32 v44, 0, v44
    v_add_f32 v44, 0x3727c5ac, v44
    v_rsq_f32 v44, v44
    v_mul_f32 v40, -1.0, v40
    v_mul_f32 v41, 0x3b000000, v41
    v_mul_f32 v45, 0x3b000000, v45
    v_fma_f32 v45, -v41, v41, v45
    v_max_f32 v45, 0, v45
    v_add_f32 v45, 0x3727c5ac, v45
    v_rsq_f32 v45, v45
    v_mul_f32 v41, -1.0, v41
    v_mul_f32 v42, 0x3b000000, v42
    v_mul_f32 v46, 0x3b000000, v46
    v_fma_f32 v46, -v42, v42, v46
    v_max_f32 v46, 0, v46
    v_add_f32 v46, 0x3727c5ac, v46
    v_rsq_f32 v46, v46
    v_mul_f32 v42, -1.0, v42
    v_mul_f32 v43, 0x3b000000, v43
    v_mul_f32 v47, 0x3b000000, v47
    v_fma_f32 v47, -v43, v43, v47
    v_max_f32 v47, 0, v47
    v_add_f32 v47, 0x3727c5ac, v47
    v_rsq_f32 v47, v47
    v_mul_f32 v43, -1.0, v43
    s_nop 1
    ds_write_b32 v49, v44 offset:0
    ds_write_b32 v49, v40 offset:512
    ds_write_b32 v49, v45 offset:32
    ds_write_b32 v49, v41 offset:544
    ds_write_b32 v49, v46 offset:64
    ds_write_b32 v49, v42 offset:576
    ds_write_b32 v49, v47 offset:96
    ds_write_b32 v49, v43 offset:608
    s_waitcnt lgkmcnt(0)
    s_barrier
    s_barrier
    s_barrier
    s_cmp_lg_u32 s60, 4
    s_cbranch_scc1 P1D_1
    s_mov_b32 s4, s34
    s_mov_b32 s5, s35
    s_mov_b32 s6, 0x100
    s_mov_b32 s7, 0x00020000
    s_mov_b64 exec, 1
    v_mov_b32 v254, 0
    v_mov_b32 v255, 0x10000
    buffer_atomic_add v255, v254, s[4:7], 0 offen sc0 sc1
    s_waitcnt vmcnt(0)
    v_readfirstlane_b32 s14, v255
    s_mov_b64 exec, -1
    s_mov_b32 s59, s14
    s_add_u32 s4, s36, 0x1e08000
    s_addc_u32 s5, s37, 0
    s_mov_b32 s6, 0x8000
    s_mov_b32 s7, 0x00020000
    v_and_b32 v253, 63, v0
    v_and_b32 v254, 15, v253
    v_lshrrev_b32 v255, 4, v253
    v_lshl_add_u32 v254, v255, 5, v254
    v_lshlrev_b32 v254, 7, v254
    v_mov_b32 v255, 1
    s_lshr_b32 s15, s14, 16
    s_cmpk_lg_u32 s15, 255
    s_cbranch_scc1 P1D_1
    s_movk_i32 s15, 0x800
    buffer_store_dword v255, v254, s[4:7], s15 offen sc0 sc1
    s_movk_i32 s15, 0x4800
    buffer_store_dword v255, v254, s[4:7], s15 offen sc0 sc1
P1D_1:
    s_branch P2_LD
K1_H_CMP:
    s_add_u32 s48, s36, 0xa00000
    s_addc_u32 s49, s37, 0
    s_mov_b32 s50, 0x800000
    s_mov_b32 s51, 0x00020000
    s_lshl_b32 s9, s6, 19
    s_mul_i32 s10, s7, 448
    s_add_u32 s9, s9, s10
    s_cmpk_ge_u32 s2, 224
    s_cbranch_scc1 PRE_A2
    s_mov_b32 s72, s30
    s_mov_b32 s73, s31
    s_mov_b32 s74, 0x1c0000
    s_mov_b32 s75, 0x00020000
    s_lshr_b32 s4, s2, 3
    s_and_b32 s5, s2, 7
    s_lshl_b32 s8, s4, 16
    s_lshl_b32 s12, s5, 7
    s_add_u32 s8, s8, s12
    s_mul_i32 s58, s5, 753664
    s_lshl_b32 s12, s4, 7
    s_add_u32 s58, s58, s12
    v_lshrrev_b32 v180, 3, v0
    v_and_b32 v181, 7, v0
    v_lshlrev_b32 v182, 10, v180
    v_lshl_add_u32 v182, v181, 4, v182
    v_add_u32 v183, 0x8000, v182
    buffer_load_dwordx4 v[160:163], v182, s[72:75], s8 offen
    buffer_load_dwordx4 v[164:167], v183, s[72:75], s8 offen
PRE_A2:
    v_and_b32 v204, 63, v0
    v_and_b32 v205, 15, v204
    v_lshrrev_b32 v206, 4, v204
    v_and_b32 v207, 7, v204
    v_xor_b32 v206, v206, v207
    v_lshlrev_b32 v206, 4, v206
    v_lshl_add_u32 v206, v205, 7, v206
    s_lshr_b32 s66, s87, 1
    s_and_b32 s67, s87, 1
    s_mul_i32 s68, s66, 14336
    s_lshl_b32 s69, s67, 13
    s_add_u32 s69, s69, 28672
    v_add_u32 v228, s69, v206
    v_add_u32 v230, s69, v206
    v_xor_b32 v230, 64, v230
    v_lshrrev_b32 v116, 4, v204
    v_lshrrev_b32 v117, 2, v205
    v_lshl_add_u32 v117, v116, 3, v117
    v_mul_u32_u24 v117, 448, v117
    v_and_b32 v232, 3, v205
    v_lshl_add_u32 v117, v232, 3, v117
    s_mul_i32 s63, s66, 224
    v_add_u32 v117, s63, v117
    v_and_b32 v116, 1, v116
    v_lshlrev_b32 v116, 5, v116
    v_add_u32 v232, v117, v116
    v_sub_u32 v233, v117, v116
    s_cmp_eq_u32 s66, 1
    s_cselect_b64 vcc, -1, 0
    v_mov_b32 v116, v232
    v_cndmask_b32 v232, v232, v233, vcc
    v_cndmask_b32 v233, v233, v116, vcc
    v_mov_b32 v208, 0
    v_mov_b32 v209, 0
    v_mov_b32 v210, 0
    v_mov_b32 v211, 0
    v_mov_b32 v212, 0
    v_mov_b32 v213, 0
    v_mov_b32 v214, 0
    v_mov_b32 v215, 0
    v_mov_b32 v216, 0
    v_mov_b32 v217, 0
    v_mov_b32 v218, 0
    v_mov_b32 v219, 0
    v_mov_b32 v220, 0
    v_mov_b32 v221, 0
    v_mov_b32 v222, 0
    v_mov_b32 v223, 0
    v_mov_b32 v224, 0x3f803f80
    v_mov_b32 v225, 0x3f803f80
    v_mov_b32 v226, 0x3f803f80
    v_mov_b32 v227, 0x3f803f80
    v_mov_b32 v4, 0
    v_mov_b32 v5, 0
    v_mov_b32 v6, 0
    v_mov_b32 v7, 0
    v_mov_b32 v8, 0
    v_mov_b32 v9, 0
    v_mov_b32 v10, 0
    v_mov_b32 v11, 0
    v_mov_b32 v12, 0
    v_mov_b32 v13, 0
    v_mov_b32 v14, 0
    v_mov_b32 v15, 0
    v_mov_b32 v16, 0
    v_mov_b32 v17, 0
    v_mov_b32 v18, 0
    v_mov_b32 v19, 0
    v_mov_b32 v20, 0
    v_mov_b32 v21, 0
    v_mov_b32 v22, 0
    v_mov_b32 v23, 0
    v_mov_b32 v24, 0
    v_mov_b32 v25, 0
    v_mov_b32 v26, 0
    v_mov_b32 v27, 0
    v_mov_b32 v28, 0
    v_mov_b32 v29, 0
    v_mov_b32 v30, 0
    v_mov_b32 v31, 0
    v_mov_b32 v32, 0
    v_mov_b32 v33, 0
    v_mov_b32 v34, 0
    v_mov_b32 v35, 0
    v_mov_b32 v36, 0
    v_mov_b32 v37, 0
    v_mov_b32 v38, 0
    v_mov_b32 v39, 0
    v_mov_b32 v40, 0
    v_mov_b32 v41, 0
    v_mov_b32 v42, 0
    v_mov_b32 v43, 0
    v_mov_b32 v44, 0
    v_mov_b32 v45, 0
    v_mov_b32 v46, 0
    v_mov_b32 v47, 0
    v_mov_b32 v48, 0
    v_mov_b32 v49, 0
    v_mov_b32 v50, 0
    v_mov_b32 v51, 0
    v_mov_b32 v52, 0
    v_mov_b32 v53, 0
    v_mov_b32 v54, 0
    v_mov_b32 v55, 0
    v_mov_b32 v56, 0
    v_mov_b32 v57, 0
    v_mov_b32 v58, 0
    v_mov_b32 v59, 0
    v_mov_b32 v60, 0
    v_mov_b32 v61, 0
    v_mov_b32 v62, 0
    v_mov_b32 v63, 0
    v_mov_b32 v64, 0
    v_mov_b32 v65, 0
    v_mov_b32 v66, 0
    v_mov_b32 v67, 0
    v_mov_b32 v68, 0
    v_mov_b32 v69, 0
    v_mov_b32 v70, 0
    v_mov_b32 v71, 0
    v_mov_b32 v72, 0
    v_mov_b32 v73, 0
    v_mov_b32 v74, 0
    v_mov_b32 v75, 0
    v_mov_b32 v76, 0
    v_mov_b32 v77, 0
    v_mov_b32 v78, 0
    v_mov_b32 v79, 0
    v_mov_b32 v80, 0
    v_mov_b32 v81, 0
    v_mov_b32 v82, 0
    v_mov_b32 v83, 0
    v_mov_b32 v84, 0
    v_mov_b32 v85, 0
    v_mov_b32 v86, 0
    v_mov_b32 v87, 0
    v_mov_b32 v88, 0
    v_mov_b32 v89, 0
    v_mov_b32 v90, 0
    v_mov_b32 v91, 0
    v_mov_b32 v92, 0
    v_mov_b32 v93, 0
    v_mov_b32 v94, 0
    v_mov_b32 v95, 0
    v_mov_b32 v96, 0
    v_mov_b32 v97, 0
    v_mov_b32 v98, 0
    v_mov_b32 v99, 0
    v_mov_b32 v100, 0
    v_mov_b32 v101, 0
    v_mov_b32 v102, 0
    v_mov_b32 v103, 0
    v_mov_b32 v104, 0
    v_mov_b32 v105, 0
    v_mov_b32 v106, 0
    v_mov_b32 v107, 0
    v_mov_b32 v108, 0
    v_mov_b32 v109, 0
    v_mov_b32 v110, 0
    v_mov_b32 v111, 0
    v_mov_b32 v112, 0
    v_mov_b32 v113, 0
    v_mov_b32 v114, 0
    v_mov_b32 v115, 0
    s_mov_b32 s82, 0
    s_mov_b32 s83, 45056
    s_mov_b32 s85, 0
    s_cmpk_ge_u32 s2, 224
    s_cbranch_scc1 PRE_B3
    v_mul_u32_u24 v182, 144, v180
    v_lshl_add_u32 v182, v181, 4, v182
    v_add_u32 v182, 137216, v182
    s_waitcnt vmcnt(0)
    ds_write_b128 v182, v[160:163]
    ds_write_b128 v182, v[164:167] offset:4608
PRE_B3:
    s_cmp_lg_u32 s60, 0
    s_cbranch_scc1 PRE_F3
    s_add_u32 s72, s36, 0x1e08000
    s_addc_u32 s73, s37, 0
    s_mov_b32 s74, 0x8000
    s_mov_b32 s75, 0x00020000
    s_lshl_b32 s12, s2, 7
    v_mov_b32 v182, s12
    v_mov_b32 v183, 0
    v_lshl_add_u32 v182, v0, 2, v182
    s_mov_b32 exec_lo, -1
    s_mov_b32 exec_hi, 0
    buffer_store_dword v183, v182, s[72:75], 0 offen sc0 sc1
    s_mov_b64 exec, -1
PRE_F3:
    s_cmpk_lg_u32 s2, 0
    s_cbranch_scc1 PRE_C3
    s_add_u32 s72, s36, 0x1e00000
    s_addc_u32 s73, s37, 0
    s_mov_b32 s74, 0x8000
    s_mov_b32 s75, 0x00020000
    v_lshlrev_b32 v182, 4, v0
    v_mov_b32 v160, 0
    v_mov_b32 v161, 0
    v_mov_b32 v162, 0
    v_mov_b32 v163, 0
    s_mov_b32 s12, 0
    buffer_store_dwordx4 v[160:163], v182, s[72:75], s12 offen sc0 sc1
    s_add_u32 s12, s12, 4096
    buffer_store_dwordx4 v[160:163], v182, s[72:75], s12 offen sc0 sc1
    s_add_u32 s12, s12, 4096
    buffer_store_dwordx4 v[160:163], v182, s[72:75], s12 offen sc0 sc1
    s_add_u32 s12, s12, 4096
    buffer_store_dwordx4 v[160:163], v182, s[72:75], s12 offen sc0 sc1
    s_add_u32 s12, s12, 4096
    buffer_store_dwordx4 v[160:163], v182, s[72:75], s12 offen sc0 sc1
    s_add_u32 s12, s12, 4096
    buffer_store_dwordx4 v[160:163], v182, s[72:75], s12 offen sc0 sc1
    s_add_u32 s12, s12, 4096
    buffer_store_dwordx4 v[160:163], v182, s[72:75], s12 offen sc0 sc1
    s_add_u32 s12, s12, 4096
    buffer_store_dwordx4 v[160:163], v182, s[72:75], s12 offen sc0 sc1
    s_add_u32 s12, s12, 4096
PRE_C3:
    s_waitcnt lgkmcnt(0)
    s_barrier
    v_add_u32 v234, s82, v232
    v_add_u32 v235, s82, v233
    v_add_u32 v229, s82, v228
    ds_read_b64_tr_b16 v[116:117], v234 offset:0
    ds_read_b64_tr_b16 v[118:119], v234 offset:1792
    ds_read_b128 v[144:147], v229 offset:0
    ds_read_b128 v[148:151], v229 offset:2048
    ds_read_b128 v[152:155], v229 offset:4096
    ds_read_b128 v[156:159], v229 offset:6144
    ds_read_b64_tr_b16 v[120:121], v235 offset:32
    ds_read_b64_tr_b16 v[122:123], v235 offset:1824
    ds_read_b64_tr_b16 v[124:125], v234 offset:64
    ds_read_b64_tr_b16 v[126:127], v234 offset:1856
    ds_read_b64_tr_b16 v[128:129], v235 offset:96
    ds_read_b64_tr_b16 v[130:131], v235 offset:1888
    ds_read_b64_tr_b16 v[132:133], v234 offset:128
    ds_read_b64_tr_b16 v[134:135], v234 offset:1920
    ds_read_b64_tr_b16 v[136:137], v235 offset:160
    ds_read_b64_tr_b16 v[138:139], v235 offset:1952
    ds_read_b64_tr_b16 v[140:141], v234 offset:192
    ds_read_b64_tr_b16 v[142:143], v234 offset:1984
    s_cmpk_ge_u32 s2, 224
    s_cbranch_scc1 POST_A4
    s_add_u32 s72, s36, 0x402000
    s_addc_u32 s73, s37, 0
    s_mov_b32 s74, 0x5be000
    s_mov_b32 s75, 0x00020000
    v_mul_u32_u24 v182, 1152, v181
    v_lshl_add_u32 v182, v180, 1, v182
    v_add_u32 v182, 137216, v182
    ds_read_u16 v160, v182 offset:0
    ds_read_u16 v168, v182 offset:144
    ds_read_u16 v161, v182 offset:288
    ds_read_u16 v169, v182 offset:432
    ds_read_u16 v162, v182 offset:576
    ds_read_u16 v170, v182 offset:720
    ds_read_u16 v163, v182 offset:864
    ds_read_u16 v171, v182 offset:1008
    ds_read_u16 v164, v182 offset:64
    ds_read_u16 v172, v182 offset:208
    ds_read_u16 v165, v182 offset:352
    ds_read_u16 v173, v182 offset:496
    ds_read_u16 v166, v182 offset:640
    ds_read_u16 v174, v182 offset:784
    ds_read_u16 v167, v182 offset:928
    ds_read_u16 v175, v182 offset:1072
    s_mov_b32 s12, 11776
    v_mul_lo_u32 v183, v180, s12
    v_lshl_add_u32 v183, v181, 4, v183
    v_add_u32 v182, 376832, v183
    s_waitcnt lgkmcnt(0)
    v_lshl_or_b32 v160, v168, 16, v160
    v_lshl_or_b32 v161, v169, 16, v161
    v_lshl_or_b32 v162, v170, 16, v162
    v_lshl_or_b32 v163, v171, 16, v163
    v_lshl_or_b32 v164, v172, 16, v164
    v_lshl_or_b32 v165, v173, 16, v165
    v_lshl_or_b32 v166, v174, 16, v166
    v_lshl_or_b32 v167, v175, 16, v167
    buffer_store_dwordx4 v[160:163], v183, s[72:75], s58 offen sc0 sc1
    buffer_store_dwordx4 v[164:167], v182, s[72:75], s58 offen sc0 sc1
POST_A4:
    v_add_u32 v234, s82, v232
    v_add_u32 v235, s82, v233
    v_add_u32 v231, s82, v230
LOOP_h:
    s_waitcnt lgkmcnt(12)
    v_mfma_f32_16x16x32_bf16 v[4:7], v[116:119], v[144:147], v[4:7]
    ds_read_b64_tr_b16 v[160:161], v234 offset:14336
    v_mfma_f32_16x16x32_bf16 v[8:11], v[116:119], v[148:151], v[8:11]
    ds_read_b64_tr_b16 v[162:163], v234 offset:16128
    v_mfma_f32_16x16x32_bf16 v[12:15], v[116:119], v[152:155], v[12:15]
    ds_read_b128 v[188:191], v231 offset:0
    v_mfma_f32_16x16x32_bf16 v[16:19], v[116:119], v[156:159], v[16:19]
    ds_read_b128 v[192:195], v231 offset:2048
    s_waitcnt lgkmcnt(14)
    v_mfma_f32_16x16x32_bf16 v[20:23], v[120:123], v[144:147], v[20:23]
    ds_read_b128 v[196:199], v231 offset:4096
    v_mfma_f32_16x16x32_bf16 v[24:27], v[120:123], v[148:151], v[24:27]
    ds_read_b128 v[200:203], v231 offset:6144
    v_mfma_f32_16x16x32_bf16 v[28:31], v[120:123], v[152:155], v[28:31]
    ds_read_b64_tr_b16 v[164:165], v235 offset:14368
    v_mfma_f32_16x16x32_bf16 v[32:35], v[120:123], v[156:159], v[32:35]
    ds_read_b64_tr_b16 v[166:167], v235 offset:16160
    s_waitcnt lgkmcnt(15)
    v_mfma_f32_16x16x32_bf16 v[36:39], v[124:127], v[144:147], v[36:39]
    ds_read_b64_tr_b16 v[168:169], v234 offset:14400
    v_mfma_f32_16x16x32_bf16 v[40:43], v[124:127], v[148:151], v[40:43]
    ds_read_b64_tr_b16 v[170:171], v234 offset:16192
    v_mfma_f32_16x16x32_bf16 v[44:47], v[124:127], v[152:155], v[44:47]
    ds_read_b64_tr_b16 v[172:173], v235 offset:14432
    v_mfma_f32_16x16x32_bf16 v[48:51], v[124:127], v[156:159], v[48:51]
    ds_read_b64_tr_b16 v[174:175], v235 offset:16224
    s_waitcnt lgkmcnt(15)
    v_mfma_f32_16x16x32_bf16 v[52:55], v[128:131], v[144:147], v[52:55]
    ds_read_b64_tr_b16 v[176:177], v234 offset:14464
    v_mfma_f32_16x16x32_bf16 v[56:59], v[128:131], v[148:151], v[56:59]
    ds_read_b64_tr_b16 v[178:179], v234 offset:16256
    v_mfma_f32_16x16x32_bf16 v[60:63], v[128:131], v[152:155], v[60:63]
    ds_read_b64_tr_b16 v[180:181], v235 offset:14496
    v_mfma_f32_16x16x32_bf16 v[64:67], v[128:131], v[156:159], v[64:67]
    ds_read_b64_tr_b16 v[182:183], v235 offset:16288
    s_waitcnt lgkmcnt(15)
    v_mfma_f32_16x16x32_bf16 v[68:71], v[132:135], v[144:147], v[68:71]
    ds_read_b64_tr_b16 v[184:185], v234 offset:14528
    v_mfma_f32_16x16x32_bf16 v[72:75], v[132:135], v[148:151], v[72:75]
    ds_read_b64_tr_b16 v[186:187], v234 offset:16320
    v_mfma_f32_16x16x32_bf16 v[76:79], v[132:135], v[152:155], v[76:79]
    v_add_u32 v234, s83, v232
    v_mfma_f32_16x16x32_bf16 v[80:83], v[132:135], v[156:159], v[80:83]
    v_add_u32 v235, s83, v233
    s_waitcnt lgkmcnt(15)
    v_mfma_f32_16x16x32_bf16 v[84:87], v[136:139], v[144:147], v[84:87]
    v_add_u32 v229, s83, v228
    v_mfma_f32_16x16x32_bf16 v[88:91], v[136:139], v[148:151], v[88:91]
    v_mfma_f32_16x16x32_bf16 v[92:95], v[136:139], v[152:155], v[92:95]
    v_mfma_f32_16x16x32_bf16 v[96:99], v[136:139], v[156:159], v[96:99]
    s_waitcnt lgkmcnt(15)
    v_mfma_f32_16x16x32_bf16 v[100:103], v[140:143], v[144:147], v[100:103]
    v_mfma_f32_16x16x32_bf16 v[104:107], v[140:143], v[148:151], v[104:107]
    v_mfma_f32_16x16x32_bf16 v[108:111], v[140:143], v[152:155], v[108:111]
    v_mfma_f32_16x16x32_bf16 v[112:115], v[140:143], v[156:159], v[112:115]
    s_cmp_eq_u32 s67, 0
    s_cbranch_scc1 ONA_5
    v_mfma_f32_16x16x32_bf16 v[208:211], v[132:135], v[224:227], v[208:211]
    v_mfma_f32_16x16x32_bf16 v[212:215], v[136:139], v[224:227], v[212:215]
    v_mfma_f32_16x16x32_bf16 v[216:219], v[140:143], v[224:227], v[216:219]
    s_branch ONB_5
ONA_5:
    v_mfma_f32_16x16x32_bf16 v[208:211], v[116:119], v[224:227], v[208:211]
    v_mfma_f32_16x16x32_bf16 v[212:215], v[120:123], v[224:227], v[212:215]
    v_mfma_f32_16x16x32_bf16 v[216:219], v[124:127], v[224:227], v[216:219]
    v_mfma_f32_16x16x32_bf16 v[220:223], v[128:131], v[224:227], v[220:223]
ONB_5:
    s_barrier
    s_waitcnt lgkmcnt(12)
    v_mfma_f32_16x16x32_bf16 v[4:7], v[160:163], v[188:191], v[4:7]
    ds_read_b64_tr_b16 v[116:117], v234 offset:0
    v_mfma_f32_16x16x32_bf16 v[8:11], v[160:163], v[192:195], v[8:11]
    ds_read_b64_tr_b16 v[118:119], v234 offset:1792
    v_mfma_f32_16x16x32_bf16 v[12:15], v[160:163], v[196:199], v[12:15]
    ds_read_b128 v[144:147], v229 offset:0
    v_mfma_f32_16x16x32_bf16 v[16:19], v[160:163], v[200:203], v[16:19]
    ds_read_b128 v[148:151], v229 offset:2048
    s_waitcnt lgkmcnt(14)
    v_mfma_f32_16x16x32_bf16 v[20:23], v[164:167], v[188:191], v[20:23]
    ds_read_b128 v[152:155], v229 offset:4096
    v_mfma_f32_16x16x32_bf16 v[24:27], v[164:167], v[192:195], v[24:27]
    ds_read_b128 v[156:159], v229 offset:6144
    v_mfma_f32_16x16x32_bf16 v[28:31], v[164:167], v[196:199], v[28:31]
    ds_read_b64_tr_b16 v[120:121], v235 offset:32
    v_mfma_f32_16x16x32_bf16 v[32:35], v[164:167], v[200:203], v[32:35]
    ds_read_b64_tr_b16 v[122:123], v235 offset:1824
    s_waitcnt lgkmcnt(15)
    v_mfma_f32_16x16x32_bf16 v[36:39], v[168:171], v[188:191], v[36:39]
    ds_read_b64_tr_b16 v[124:125], v234 offset:64
    v_mfma_f32_16x16x32_bf16 v[40:43], v[168:171], v[192:195], v[40:43]
    ds_read_b64_tr_b16 v[126:127], v234 offset:1856
    v_mfma_f32_16x16x32_bf16 v[44:47], v[168:171], v[196:199], v[44:47]
    ds_read_b64_tr_b16 v[128:129], v235 offset:96
    v_mfma_f32_16x16x32_bf16 v[48:51], v[168:171], v[200:203], v[48:51]
    ds_read_b64_tr_b16 v[130:131], v235 offset:1888
    s_waitcnt lgkmcnt(15)
    v_mfma_f32_16x16x32_bf16 v[52:55], v[172:175], v[188:191], v[52:55]
    ds_read_b64_tr_b16 v[132:133], v234 offset:128
    v_mfma_f32_16x16x32_bf16 v[56:59], v[172:175], v[192:195], v[56:59]
    ds_read_b64_tr_b16 v[134:135], v234 offset:1920
    v_mfma_f32_16x16x32_bf16 v[60:63], v[172:175], v[196:199], v[60:63]
    ds_read_b64_tr_b16 v[136:137], v235 offset:160
    v_mfma_f32_16x16x32_bf16 v[64:67], v[172:175], v[200:203], v[64:67]
    ds_read_b64_tr_b16 v[138:139], v235 offset:1952
    s_waitcnt lgkmcnt(15)
    v_mfma_f32_16x16x32_bf16 v[68:71], v[176:179], v[188:191], v[68:71]
    ds_read_b64_tr_b16 v[140:141], v234 offset:192
    v_mfma_f32_16x16x32_bf16 v[72:75], v[176:179], v[192:195], v[72:75]
    ds_read_b64_tr_b16 v[142:143], v234 offset:1984
    v_mfma_f32_16x16x32_bf16 v[76:79], v[176:179], v[196:199], v[76:79]
    v_add_u32 v234, s83, v232
    v_mfma_f32_16x16x32_bf16 v[80:83], v[176:179], v[200:203], v[80:83]
    v_add_u32 v235, s83, v233
    s_waitcnt lgkmcnt(15)
    v_mfma_f32_16x16x32_bf16 v[84:87], v[180:183], v[188:191], v[84:87]
    v_add_u32 v231, s83, v230
    v_mfma_f32_16x16x32_bf16 v[88:91], v[180:183], v[192:195], v[88:91]
    s_mov_b32 s82, s83
    v_mfma_f32_16x16x32_bf16 v[92:95], v[180:183], v[196:199], v[92:95]
    s_add_u32 s83, s83, 45056
    v_mfma_f32_16x16x32_bf16 v[96:99], v[180:183], v[200:203], v[96:99]
    s_cmp_eq_u32 s83, 135168
    s_waitcnt lgkmcnt(15)
    v_mfma_f32_16x16x32_bf16 v[100:103], v[184:187], v[188:191], v[100:103]
    s_cselect_b32 s83, 0, s83
    v_mfma_f32_16x16x32_bf16 v[104:107], v[184:187], v[192:195], v[104:107]
    s_add_u32 s85, s85, 1
    v_mfma_f32_16x16x32_bf16 v[108:111], v[184:187], v[196:199], v[108:111]
    v_mfma_f32_16x16x32_bf16 v[112:115], v[184:187], v[200:203], v[112:115]
    s_cmp_eq_u32 s67, 0
    s_cbranch_scc1 ONA_6
    v_mfma_f32_16x16x32_bf16 v[208:211], v[176:179], v[224:227], v[208:211]
    v_mfma_f32_16x16x32_bf16 v[212:215], v[180:183], v[224:227], v[212:215]
    v_mfma_f32_16x16x32_bf16 v[216:219], v[184:187], v[224:227], v[216:219]
    s_branch ONB_6
ONA_6:
    v_mfma_f32_16x16x32_bf16 v[208:211], v[160:163], v[224:227], v[208:211]
    v_mfma_f32_16x16x32_bf16 v[212:215], v[164:167], v[224:227], v[212:215]
    v_mfma_f32_16x16x32_bf16 v[216:219], v[168:171], v[224:227], v[216:219]
    v_mfma_f32_16x16x32_bf16 v[220:223], v[172:175], v[224:227], v[220:223]
ONB_6:
    s_cmp_lt_u32 s85, 8
    s_barrier
    s_cbranch_scc1 LOOP_h
    s_waitcnt lgkmcnt(0)
    s_nop 7
    s_nop 7
EPI_h:
    v_and_b32 v204, 63, v0
    v_and_b32 v205, 15, v204
    v_lshrrev_b32 v206, 4, v204
    s_mul_i32 s63, s66, 448
    s_lshl_b32 s64, s67, 8
    s_add_u32 s64, s64, s63
    s_add_u32 s64, s64, 136192
    v_lshlrev_b32 v207, 4, v206
    v_add_u32 v207, s64, v207
    ds_write_b128 v207, v[208:211] offset:0
    ds_write_b128 v207, v[212:215] offset:64
    ds_write_b128 v207, v[216:219] offset:128
    s_cmp_lg_u32 s67, 0
    s_cbranch_scc1 EP_S_h
    ds_write_b128 v207, v[220:223] offset:192
EP_S_h:
    s_waitcnt lgkmcnt(0)
    s_barrier
    v_lshlrev_b32 v207, 4, v206
    s_add_u32 s64, s63, 136192
    v_add_u32 v207, s64, v207
    ds_read_b128 v[116:119], v207 offset:0
    ds_read_b128 v[120:123], v207 offset:64
    ds_read_b128 v[124:127], v207 offset:128
    ds_read_b128 v[128:131], v207 offset:192
    ds_read_b128 v[132:135], v207 offset:256
    ds_read_b128 v[136:139], v207 offset:320
    ds_read_b128 v[140:143], v207 offset:384
    s_lshl_b32 s64, s67, 8
    s_add_u32 s64, s64, 135168
    v_lshlrev_b32 v207, 2, v205
    v_add_u32 v207, s64, v207
    ds_read_b32 v160, v207 offset:512
    ds_read_b32 v161, v207 offset:0
    ds_read_b32 v162, v207 offset:576
    ds_read_b32 v163, v207 offset:64
    ds_read_b32 v164, v207 offset:640
    ds_read_b32 v165, v207 offset:128
    ds_read_b32 v166, v207 offset:704
    ds_read_b32 v167, v207 offset:192
    s_lshl_b32 s63, s67, 6
    v_add_u32 v205, s63, v205
    v_mul_u32_u24 v205, 464, v205
    v_lshl_add_u32 v205, v206, 3, v205
    s_mul_i32 s63, s66, 224
    v_add_u32 v205, s63, v205
    s_waitcnt lgkmcnt(0)
    v_pk_fma_f32 v[4:5], v[116:117], v[160:161], v[4:5] op_sel_hi:[1,0,1]
    v_pk_mul_f32 v[4:5], v[4:5], v[160:161] op_sel:[0,1] op_sel_hi:[1,1]
    v_pk_fma_f32 v[6:7], v[118:119], v[160:161], v[6:7] op_sel_hi:[1,0,1]
    v_pk_mul_f32 v[6:7], v[6:7], v[160:161] op_sel:[0,1] op_sel_hi:[1,1]
    v_cvt_pk_bf16_f32 v236, v4, v5
    v_cvt_pk_bf16_f32 v237, v6, v7
    v_pk_max_i16 v236, v236, 0
    v_pk_max_i16 v237, v237, 0
    ds_write_b64 v205, v[236:237] offset:0
    v_pk_fma_f32 v[8:9], v[116:117], v[162:163], v[8:9] op_sel_hi:[1,0,1]
    v_pk_mul_f32 v[8:9], v[8:9], v[162:163] op_sel:[0,1] op_sel_hi:[1,1]
    v_pk_fma_f32 v[10:11], v[118:119], v[162:163], v[10:11] op_sel_hi:[1,0,1]
    v_pk_mul_f32 v[10:11], v[10:11], v[162:163] op_sel:[0,1] op_sel_hi:[1,1]
    v_cvt_pk_bf16_f32 v236, v8, v9
    v_cvt_pk_bf16_f32 v237, v10, v11
    v_pk_max_i16 v236, v236, 0
    v_pk_max_i16 v237, v237, 0
    ds_write_b64 v205, v[236:237] offset:7424
    v_pk_fma_f32 v[12:13], v[116:117], v[164:165], v[12:13] op_sel_hi:[1,0,1]
    v_pk_mul_f32 v[12:13], v[12:13], v[164:165] op_sel:[0,1] op_sel_hi:[1,1]
    v_pk_fma_f32 v[14:15], v[118:119], v[164:165], v[14:15] op_sel_hi:[1,0,1]
    v_pk_mul_f32 v[14:15], v[14:15], v[164:165] op_sel:[0,1] op_sel_hi:[1,1]
    v_cvt_pk_bf16_f32 v236, v12, v13
    v_cvt_pk_bf16_f32 v237, v14, v15
    v_pk_max_i16 v236, v236, 0
    v_pk_max_i16 v237, v237, 0
    ds_write_b64 v205, v[236:237] offset:14848
    v_pk_fma_f32 v[16:17], v[116:117], v[166:167], v[16:17] op_sel_hi:[1,0,1]
    v_pk_mul_f32 v[16:17], v[16:17], v[166:167] op_sel:[0,1] op_sel_hi:[1,1]
    v_pk_fma_f32 v[18:19], v[118:119], v[166:167], v[18:19] op_sel_hi:[1,0,1]
    v_pk_mul_f32 v[18:19], v[18:19], v[166:167] op_sel:[0,1] op_sel_hi:[1,1]
    v_cvt_pk_bf16_f32 v236, v16, v17
    v_cvt_pk_bf16_f32 v237, v18, v19
    v_pk_max_i16 v236, v236, 0
    v_pk_max_i16 v237, v237, 0
    ds_write_b64 v205, v[236:237] offset:22272
    v_pk_fma_f32 v[20:21], v[120:121], v[160:161], v[20:21] op_sel_hi:[1,0,1]
    v_pk_mul_f32 v[20:21], v[20:21], v[160:161] op_sel:[0,1] op_sel_hi:[1,1]
    v_pk_fma_f32 v[22:23], v[122:123], v[160:161], v[22:23] op_sel_hi:[1,0,1]
    v_pk_mul_f32 v[22:23], v[22:23], v[160:161] op_sel:[0,1] op_sel_hi:[1,1]
    v_cvt_pk_bf16_f32 v236, v20, v21
    v_cvt_pk_bf16_f32 v237, v22, v23
    v_pk_max_i16 v236, v236, 0
    v_pk_max_i16 v237, v237, 0
    ds_write_b64 v205, v[236:237] offset:32
    v_pk_fma_f32 v[24:25], v[120:121], v[162:163], v[24:25] op_sel_hi:[1,0,1]
    v_pk_mul_f32 v[24:25], v[24:25], v[162:163] op_sel:[0,1] op_sel_hi:[1,1]
    v_pk_fma_f32 v[26:27], v[122:123], v[162:163], v[26:27] op_sel_hi:[1,0,1]
    v_pk_mul_f32 v[26:27], v[26:27], v[162:163] op_sel:[0,1] op_sel_hi:[1,1]
    v_cvt_pk_bf16_f32 v236, v24, v25
    v_cvt_pk_bf16_f32 v237, v26, v27
    v_pk_max_i16 v236, v236, 0
    v_pk_max_i16 v237, v237, 0
    ds_write_b64 v205, v[236:237] offset:7456
    v_pk_fma_f32 v[28:29], v[120:121], v[164:165], v[28:29] op_sel_hi:[1,0,1]
    v_pk_mul_f32 v[28:29], v[28:29], v[164:165] op_sel:[0,1] op_sel_hi:[1,1]
    v_pk_fma_f32 v[30:31], v[122:123], v[164:165], v[30:31] op_sel_hi:[1,0,1]
    v_pk_mul_f32 v[30:31], v[30:31], v[164:165] op_sel:[0,1] op_sel_hi:[1,1]
    v_cvt_pk_bf16_f32 v236, v28, v29
    v_cvt_pk_bf16_f32 v237, v30, v31
    v_pk_max_i16 v236, v236, 0
    v_pk_max_i16 v237, v237, 0
    ds_write_b64 v205, v[236:237] offset:14880
    v_pk_fma_f32 v[32:33], v[120:121], v[166:167], v[32:33] op_sel_hi:[1,0,1]
    v_pk_mul_f32 v[32:33], v[32:33], v[166:167] op_sel:[0,1] op_sel_hi:[1,1]
    v_pk_fma_f32 v[34:35], v[122:123], v[166:167], v[34:35] op_sel_hi:[1,0,1]
    v_pk_mul_f32 v[34:35], v[34:35], v[166:167] op_sel:[0,1] op_sel_hi:[1,1]
    v_cvt_pk_bf16_f32 v236, v32, v33
    v_cvt_pk_bf16_f32 v237, v34, v35
    v_pk_max_i16 v236, v236, 0
    v_pk_max_i16 v237, v237, 0
    ds_write_b64 v205, v[236:237] offset:22304
    v_pk_fma_f32 v[36:37], v[124:125], v[160:161], v[36:37] op_sel_hi:[1,0,1]
    v_pk_mul_f32 v[36:37], v[36:37], v[160:161] op_sel:[0,1] op_sel_hi:[1,1]
    v_pk_fma_f32 v[38:39], v[126:127], v[160:161], v[38:39] op_sel_hi:[1,0,1]
    v_pk_mul_f32 v[38:39], v[38:39], v[160:161] op_sel:[0,1] op_sel_hi:[1,1]
    v_cvt_pk_bf16_f32 v236, v36, v37
    v_cvt_pk_bf16_f32 v237, v38, v39
    v_pk_max_i16 v236, v236, 0
    v_pk_max_i16 v237, v237, 0
    ds_write_b64 v205, v[236:237] offset:64
    v_pk_fma_f32 v[40:41], v[124:125], v[162:163], v[40:41] op_sel_hi:[1,0,1]
    v_pk_mul_f32 v[40:41], v[40:41], v[162:163] op_sel:[0,1] op_sel_hi:[1,1]
    v_pk_fma_f32 v[42:43], v[126:127], v[162:163], v[42:43] op_sel_hi:[1,0,1]
    v_pk_mul_f32 v[42:43], v[42:43], v[162:163] op_sel:[0,1] op_sel_hi:[1,1]
    v_cvt_pk_bf16_f32 v236, v40, v41
    v_cvt_pk_bf16_f32 v237, v42, v43
    v_pk_max_i16 v236, v236, 0
    v_pk_max_i16 v237, v237, 0
    ds_write_b64 v205, v[236:237] offset:7488
    v_pk_fma_f32 v[44:45], v[124:125], v[164:165], v[44:45] op_sel_hi:[1,0,1]
    v_pk_mul_f32 v[44:45], v[44:45], v[164:165] op_sel:[0,1] op_sel_hi:[1,1]
    v_pk_fma_f32 v[46:47], v[126:127], v[164:165], v[46:47] op_sel_hi:[1,0,1]
    v_pk_mul_f32 v[46:47], v[46:47], v[164:165] op_sel:[0,1] op_sel_hi:[1,1]
    v_cvt_pk_bf16_f32 v236, v44, v45
    v_cvt_pk_bf16_f32 v237, v46, v47
    v_pk_max_i16 v236, v236, 0
    v_pk_max_i16 v237, v237, 0
    ds_write_b64 v205, v[236:237] offset:14912
    v_pk_fma_f32 v[48:49], v[124:125], v[166:167], v[48:49] op_sel_hi:[1,0,1]
    v_pk_mul_f32 v[48:49], v[48:49], v[166:167] op_sel:[0,1] op_sel_hi:[1,1]
    v_pk_fma_f32 v[50:51], v[126:127], v[166:167], v[50:51] op_sel_hi:[1,0,1]
    v_pk_mul_f32 v[50:51], v[50:51], v[166:167] op_sel:[0,1] op_sel_hi:[1,1]
    v_cvt_pk_bf16_f32 v236, v48, v49
    v_cvt_pk_bf16_f32 v237, v50, v51
    v_pk_max_i16 v236, v236, 0
    v_pk_max_i16 v237, v237, 0
    ds_write_b64 v205, v[236:237] offset:22336
    v_pk_fma_f32 v[52:53], v[128:129], v[160:161], v[52:53] op_sel_hi:[1,0,1]
    v_pk_mul_f32 v[52:53], v[52:53], v[160:161] op_sel:[0,1] op_sel_hi:[1,1]
    v_pk_fma_f32 v[54:55], v[130:131], v[160:161], v[54:55] op_sel_hi:[1,0,1]
    v_pk_mul_f32 v[54:55], v[54:55], v[160:161] op_sel:[0,1] op_sel_hi:[1,1]
    v_cvt_pk_bf16_f32 v236, v52, v53
    v_cvt_pk_bf16_f32 v237, v54, v55
    v_pk_max_i16 v236, v236, 0
    v_pk_max_i16 v237, v237, 0
    ds_write_b64 v205, v[236:237] offset:96
    v_pk_fma_f32 v[56:57], v[128:129], v[162:163], v[56:57] op_sel_hi:[1,0,1]
    v_pk_mul_f32 v[56:57], v[56:57], v[162:163] op_sel:[0,1] op_sel_hi:[1,1]
    v_pk_fma_f32 v[58:59], v[130:131], v[162:163], v[58:59] op_sel_hi:[1,0,1]
    v_pk_mul_f32 v[58:59], v[58:59], v[162:163] op_sel:[0,1] op_sel_hi:[1,1]
    v_cvt_pk_bf16_f32 v236, v56, v57
    v_cvt_pk_bf16_f32 v237, v58, v59
    v_pk_max_i16 v236, v236, 0
    v_pk_max_i16 v237, v237, 0
    ds_write_b64 v205, v[236:237] offset:7520
    v_pk_fma_f32 v[60:61], v[128:129], v[164:165], v[60:61] op_sel_hi:[1,0,1]
    v_pk_mul_f32 v[60:61], v[60:61], v[164:165] op_sel:[0,1] op_sel_hi:[1,1]
    v_pk_fma_f32 v[62:63], v[130:131], v[164:165], v[62:63] op_sel_hi:[1,0,1]
    v_pk_mul_f32 v[62:63], v[62:63], v[164:165] op_sel:[0,1] op_sel_hi:[1,1]
    v_cvt_pk_bf16_f32 v236, v60, v61
    v_cvt_pk_bf16_f32 v237, v62, v63
    v_pk_max_i16 v236, v236, 0
    v_pk_max_i16 v237, v237, 0
    ds_write_b64 v205, v[236:237] offset:14944
    v_pk_fma_f32 v[64:65], v[128:129], v[166:167], v[64:65] op_sel_hi:[1,0,1]
    v_pk_mul_f32 v[64:65], v[64:65], v[166:167] op_sel:[0,1] op_sel_hi:[1,1]
    v_pk_fma_f32 v[66:67], v[130:131], v[166:167], v[66:67] op_sel_hi:[1,0,1]
    v_pk_mul_f32 v[66:67], v[66:67], v[166:167] op_sel:[0,1] op_sel_hi:[1,1]
    v_cvt_pk_bf16_f32 v236, v64, v65
    v_cvt_pk_bf16_f32 v237, v66, v67
    v_pk_max_i16 v236, v236, 0
    v_pk_max_i16 v237, v237, 0
    ds_write_b64 v205, v[236:237] offset:22368
    v_pk_fma_f32 v[68:69], v[132:133], v[160:161], v[68:69] op_sel_hi:[1,0,1]
    v_pk_mul_f32 v[68:69], v[68:69], v[160:161] op_sel:[0,1] op_sel_hi:[1,1]
    v_pk_fma_f32 v[70:71], v[134:135], v[160:161], v[70:71] op_sel_hi:[1,0,1]
    v_pk_mul_f32 v[70:71], v[70:71], v[160:161] op_sel:[0,1] op_sel_hi:[1,1]
    v_cvt_pk_bf16_f32 v236, v68, v69
    v_cvt_pk_bf16_f32 v237, v70, v71
    v_pk_max_i16 v236, v236, 0
    v_pk_max_i16 v237, v237, 0
    ds_write_b64 v205, v[236:237] offset:128
    v_pk_fma_f32 v[72:73], v[132:133], v[162:163], v[72:73] op_sel_hi:[1,0,1]
    v_pk_mul_f32 v[72:73], v[72:73], v[162:163] op_sel:[0,1] op_sel_hi:[1,1]
    v_pk_fma_f32 v[74:75], v[134:135], v[162:163], v[74:75] op_sel_hi:[1,0,1]
    v_pk_mul_f32 v[74:75], v[74:75], v[162:163] op_sel:[0,1] op_sel_hi:[1,1]
    v_cvt_pk_bf16_f32 v236, v72, v73
    v_cvt_pk_bf16_f32 v237, v74, v75
    v_pk_max_i16 v236, v236, 0
    v_pk_max_i16 v237, v237, 0
    ds_write_b64 v205, v[236:237] offset:7552
    v_pk_fma_f32 v[76:77], v[132:133], v[164:165], v[76:77] op_sel_hi:[1,0,1]
    v_pk_mul_f32 v[76:77], v[76:77], v[164:165] op_sel:[0,1] op_sel_hi:[1,1]
    v_pk_fma_f32 v[78:79], v[134:135], v[164:165], v[78:79] op_sel_hi:[1,0,1]
    v_pk_mul_f32 v[78:79], v[78:79], v[164:165] op_sel:[0,1] op_sel_hi:[1,1]
    v_cvt_pk_bf16_f32 v236, v76, v77
    v_cvt_pk_bf16_f32 v237, v78, v79
    v_pk_max_i16 v236, v236, 0
    v_pk_max_i16 v237, v237, 0
    ds_write_b64 v205, v[236:237] offset:14976
    v_pk_fma_f32 v[80:81], v[132:133], v[166:167], v[80:81] op_sel_hi:[1,0,1]
    v_pk_mul_f32 v[80:81], v[80:81], v[166:167] op_sel:[0,1] op_sel_hi:[1,1]
    v_pk_fma_f32 v[82:83], v[134:135], v[166:167], v[82:83] op_sel_hi:[1,0,1]
    v_pk_mul_f32 v[82:83], v[82:83], v[166:167] op_sel:[0,1] op_sel_hi:[1,1]
    v_cvt_pk_bf16_f32 v236, v80, v81
    v_cvt_pk_bf16_f32 v237, v82, v83
    v_pk_max_i16 v236, v236, 0
    v_pk_max_i16 v237, v237, 0
    ds_write_b64 v205, v[236:237] offset:22400
    v_pk_fma_f32 v[84:85], v[136:137], v[160:161], v[84:85] op_sel_hi:[1,0,1]
    v_pk_mul_f32 v[84:85], v[84:85], v[160:161] op_sel:[0,1] op_sel_hi:[1,1]
    v_pk_fma_f32 v[86:87], v[138:139], v[160:161], v[86:87] op_sel_hi:[1,0,1]
    v_pk_mul_f32 v[86:87], v[86:87], v[160:161] op_sel:[0,1] op_sel_hi:[1,1]
    v_cvt_pk_bf16_f32 v236, v84, v85
    v_cvt_pk_bf16_f32 v237, v86, v87
    v_pk_max_i16 v236, v236, 0
    v_pk_max_i16 v237, v237, 0
    ds_write_b64 v205, v[236:237] offset:160
    v_pk_fma_f32 v[88:89], v[136:137], v[162:163], v[88:89] op_sel_hi:[1,0,1]
    v_pk_mul_f32 v[88:89], v[88:89], v[162:163] op_sel:[0,1] op_sel_hi:[1,1]
    v_pk_fma_f32 v[90:91], v[138:139], v[162:163], v[90:91] op_sel_hi:[1,0,1]
    v_pk_mul_f32 v[90:91], v[90:91], v[162:163] op_sel:[0,1] op_sel_hi:[1,1]
    v_cvt_pk_bf16_f32 v236, v88, v89
    v_cvt_pk_bf16_f32 v237, v90, v91
    v_pk_max_i16 v236, v236, 0
    v_pk_max_i16 v237, v237, 0
    ds_write_b64 v205, v[236:237] offset:7584
    v_pk_fma_f32 v[92:93], v[136:137], v[164:165], v[92:93] op_sel_hi:[1,0,1]
    v_pk_mul_f32 v[92:93], v[92:93], v[164:165] op_sel:[0,1] op_sel_hi:[1,1]
    v_pk_fma_f32 v[94:95], v[138:139], v[164:165], v[94:95] op_sel_hi:[1,0,1]
    v_pk_mul_f32 v[94:95], v[94:95], v[164:165] op_sel:[0,1] op_sel_hi:[1,1]
    v_cvt_pk_bf16_f32 v236, v92, v93
    v_cvt_pk_bf16_f32 v237, v94, v95
    v_pk_max_i16 v236, v236, 0
    v_pk_max_i16 v237, v237, 0
    ds_write_b64 v205, v[236:237] offset:15008
    v_pk_fma_f32 v[96:97], v[136:137], v[166:167], v[96:97] op_sel_hi:[1,0,1]
    v_pk_mul_f32 v[96:97], v[96:97], v[166:167] op_sel:[0,1] op_sel_hi:[1,1]
    v_pk_fma_f32 v[98:99], v[138:139], v[166:167], v[98:99] op_sel_hi:[1,0,1]
    v_pk_mul_f32 v[98:99], v[98:99], v[166:167] op_sel:[0,1] op_sel_hi:[1,1]
    v_cvt_pk_bf16_f32 v236, v96, v97
    v_cvt_pk_bf16_f32 v237, v98, v99
    v_pk_max_i16 v236, v236, 0
    v_pk_max_i16 v237, v237, 0
    ds_write_b64 v205, v[236:237] offset:22432
    v_pk_fma_f32 v[100:101], v[140:141], v[160:161], v[100:101] op_sel_hi:[1,0,1]
    v_pk_mul_f32 v[100:101], v[100:101], v[160:161] op_sel:[0,1] op_sel_hi:[1,1]
    v_pk_fma_f32 v[102:103], v[142:143], v[160:161], v[102:103] op_sel_hi:[1,0,1]
    v_pk_mul_f32 v[102:103], v[102:103], v[160:161] op_sel:[0,1] op_sel_hi:[1,1]
    v_cvt_pk_bf16_f32 v236, v100, v101
    v_cvt_pk_bf16_f32 v237, v102, v103
    v_pk_max_i16 v236, v236, 0
    v_pk_max_i16 v237, v237, 0
    ds_write_b64 v205, v[236:237] offset:192
    v_pk_fma_f32 v[104:105], v[140:141], v[162:163], v[104:105] op_sel_hi:[1,0,1]
    v_pk_mul_f32 v[104:105], v[104:105], v[162:163] op_sel:[0,1] op_sel_hi:[1,1]
    v_pk_fma_f32 v[106:107], v[142:143], v[162:163], v[106:107] op_sel_hi:[1,0,1]
    v_pk_mul_f32 v[106:107], v[106:107], v[162:163] op_sel:[0,1] op_sel_hi:[1,1]
    v_cvt_pk_bf16_f32 v236, v104, v105
    v_cvt_pk_bf16_f32 v237, v106, v107
    v_pk_max_i16 v236, v236, 0
    v_pk_max_i16 v237, v237, 0
    ds_write_b64 v205, v[236:237] offset:7616
    v_pk_fma_f32 v[108:109], v[140:141], v[164:165], v[108:109] op_sel_hi:[1,0,1]
    v_pk_mul_f32 v[108:109], v[108:109], v[164:165] op_sel:[0,1] op_sel_hi:[1,1]
    v_pk_fma_f32 v[110:111], v[142:143], v[164:165], v[110:111] op_sel_hi:[1,0,1]
    v_pk_mul_f32 v[110:111], v[110:111], v[164:165] op_sel:[0,1] op_sel_hi:[1,1]
    v_cvt_pk_bf16_f32 v236, v108, v109
    v_cvt_pk_bf16_f32 v237, v110, v111
    v_pk_max_i16 v236, v236, 0
    v_pk_max_i16 v237, v237, 0
    ds_write_b64 v205, v[236:237] offset:15040
    v_pk_fma_f32 v[112:113], v[140:141], v[166:167], v[112:113] op_sel_hi:[1,0,1]
    v_pk_mul_f32 v[112:113], v[112:113], v[166:167] op_sel:[0,1] op_sel_hi:[1,1]
    v_pk_fma_f32 v[114:115], v[142:143], v[166:167], v[114:115] op_sel_hi:[1,0,1]
    v_pk_mul_f32 v[114:115], v[114:115], v[166:167] op_sel:[0,1] op_sel_hi:[1,1]
    v_cvt_pk_bf16_f32 v236, v112, v113
    v_cvt_pk_bf16_f32 v237, v114, v115
    v_pk_max_i16 v236, v236, 0
    v_pk_max_i16 v237, v237, 0
    ds_write_b64 v205, v[236:237] offset:22464
    s_waitcnt lgkmcnt(0)
    s_barrier
    v_and_b32 v205, 31, v0
    v_lshrrev_b32 v206, 5, v0
    v_mul_u32_u24 v207, 464, v206
    v_lshl_add_u32 v207, v205, 4, v207
    s_mov_b32 s63, 4096
    v_mul_lo_u32 v206, v206, s63
    v_lshl_add_u32 v206, v205, 4, v206
    v_cmp_gt_u32 vcc, 28, v205
    s_and_saveexec_b64 s[72:73], vcc
    ds_read_b128 v[4:7], v207 offset:0
    ds_read_b128 v[8:11], v207 offset:3712
    ds_read_b128 v[12:15], v207 offset:7424
    ds_read_b128 v[16:19], v207 offset:11136
    ds_read_b128 v[20:23], v207 offset:14848
    ds_read_b128 v[24:27], v207 offset:18560
    ds_read_b128 v[28:31], v207 offset:22272
    ds_read_b128 v[32:35], v207 offset:25984
    ds_read_b128 v[36:39], v207 offset:29696
    ds_read_b128 v[40:43], v207 offset:33408
    ds_read_b128 v[44:47], v207 offset:37120
    ds_read_b128 v[48:51], v207 offset:40832
    ds_read_b128 v[52:55], v207 offset:44544
    ds_read_b128 v[56:59], v207 offset:48256
    ds_read_b128 v[60:63], v207 offset:51968
    ds_read_b128 v[64:67], v207 offset:55680
    s_waitcnt lgkmcnt(15)
    s_add_u32 s63, s9, 0
    buffer_store_dwordx4 v[4:7], v206, s[48:51], s63 offen sc0 sc1
    s_waitcnt lgkmcnt(14)
    s_add_u32 s63, s9, 32768
    buffer_store_dwordx4 v[8:11], v206, s[48:51], s63 offen sc0 sc1
    s_waitcnt lgkmcnt(13)
    s_add_u32 s63, s9, 65536
    buffer_store_dwordx4 v[12:15], v206, s[48:51], s63 offen sc0 sc1
    s_waitcnt lgkmcnt(12)
    s_add_u32 s63, s9, 98304
    buffer_store_dwordx4 v[16:19], v206, s[48:51], s63 offen sc0 sc1
    s_waitcnt lgkmcnt(11)
    s_add_u32 s63, s9, 131072
    buffer_store_dwordx4 v[20:23], v206, s[48:51], s63 offen sc0 sc1
    s_waitcnt lgkmcnt(10)
    s_add_u32 s63, s9, 163840
    buffer_store_dwordx4 v[24:27], v206, s[48:51], s63 offen sc0 sc1
    s_waitcnt lgkmcnt(9)
    s_add_u32 s63, s9, 196608
    buffer_store_dwordx4 v[28:31], v206, s[48:51], s63 offen sc0 sc1
    s_waitcnt lgkmcnt(8)
    s_add_u32 s63, s9, 229376
    buffer_store_dwordx4 v[32:35], v206, s[48:51], s63 offen sc0 sc1
    s_waitcnt lgkmcnt(7)
    s_add_u32 s63, s9, 262144
    buffer_store_dwordx4 v[36:39], v206, s[48:51], s63 offen sc0 sc1
    s_waitcnt lgkmcnt(6)
    s_add_u32 s63, s9, 294912
    buffer_store_dwordx4 v[40:43], v206, s[48:51], s63 offen sc0 sc1
    s_waitcnt lgkmcnt(5)
    s_add_u32 s63, s9, 327680
    buffer_store_dwordx4 v[44:47], v206, s[48:51], s63 offen sc0 sc1
    s_waitcnt lgkmcnt(4)
    s_add_u32 s63, s9, 360448
    buffer_store_dwordx4 v[48:51], v206, s[48:51], s63 offen sc0 sc1
    s_waitcnt lgkmcnt(3)
    s_add_u32 s63, s9, 393216
    buffer_store_dwordx4 v[52:55], v206, s[48:51], s63 offen sc0 sc1
    s_waitcnt lgkmcnt(2)
    s_add_u32 s63, s9, 425984
    buffer_store_dwordx4 v[56:59], v206, s[48:51], s63 offen sc0 sc1
    s_waitcnt lgkmcnt(1)
    s_add_u32 s63, s9, 458752
    buffer_store_dwordx4 v[60:63], v206, s[48:51], s63 offen sc0 sc1
    s_waitcnt lgkmcnt(0)
    s_add_u32 s63, s9, 491520
    buffer_store_dwordx4 v[64:67], v206, s[48:51], s63 offen sc0 sc1
    s_mov_b64 exec, s[72:73]
    s_waitcnt vmcnt(0)
    s_barrier
    s_branch P2_CMP
K1_AB:
    s_mov_b32 s40, s16
    s_mov_b32 s41, s17
    s_mov_b32 s42, 0x200000
    s_mov_b32 s43, 0x00020000
    s_cmp_lt_u32 s7, 4
    s_cselect_b32 s44, s22, s24
    s_cselect_b32 s45, s23, s25
    s_mov_b32 s46, 0x80000
    s_mov_b32 s47, 0x00020000
    s_cselect_b32 s70, 0x3f800000, 0xbf800000
    s_cselect_b32 s71, 0, 4096
    s_lshl_b32 s61, s6, 17
    s_and_b32 s13, s7, 3
    s_lshl_b32 s62, s13, 17
    s_mov_b32 s11, 0
    s_cmp_lt_u32 s60, 4
    s_cbranch_scc1 K1_AB_CMP
    v_and_b32 v2, 63, v0
    v_lshrrev_b32 v3, 3, v2
    v_and_b32 v4, 7, v2
    v_xor_b32 v4, v4, v3
    v_lshlrev_b32 v4, 4, v4
    s_mul_i32 s63, s87, 32
    v_add_u32 v5, s63, v3
    s_mov_b32 s63, 1024
    v_mul_lo_u32 v5, v5, s63
    v_add_u32 v5, v5, v4
    v_add_u32 v5, s61, v5
    v_mov_b32 v8, v5
    v_add_u32 v9, 0x1c00, v5
    v_add_u32 v10, 0x3800, v5
    v_add_u32 v11, 0x5400, v5
    s_lshl_b32 s63, s87, 5
    v_add_u32 v5, s63, v3
    s_mov_b32 s63, 1024
    v_mul_lo_u32 v5, v5, s63
    v_add_u32 v5, v5, v4
    v_add_u32 v5, s62, v5
    v_mov_b32 v12, v5
    v_add_u32 v13, 0x1c00, v5
    v_add_u32 v14, 0x3800, v5
    v_add_u32 v15, 0x5400, v5
    s_mul_i32 s64, s87, 4096
    s_lshl_b32 s65, s87, 12
    s_add_u32 s65, s65, 16384
    v_lshlrev_b32 v48, 4, v2
    s_lshl_b32 s63, s87, 12
    s_add_u32 s63, s63, 0
    v_add_u32 v48, s63, v48
    v_mov_b32 v40, 0
    v_mov_b32 v41, 0
    v_mov_b32 v42, 0
    v_mov_b32 v43, 0
    v_mov_b32 v44, 0
    v_mov_b32 v45, 0
    v_mov_b32 v46, 0
    v_mov_b32 v47, 0
    s_mov_b32 s86, 0
    s_mov_b32 s88, 0x3f803f80
    s_mov_b32 s84, 0
    s_add_u32 m0, s84, s64
    s_nop 0
    buffer_load_dwordx4 v8, s[40:43], s11 offen offset:0 lds
    buffer_load_dwordx4 v9, s[40:43], s11 offen offset:1024 lds
    buffer_load_dwordx4 v10, s[40:43], s11 offen offset:2048 lds
    buffer_load_dwordx4 v11, s[40:43], s11 offen offset:3072 lds
    s_add_u32 m0, s84, s65
    s_nop 0
    buffer_load_dwordx4 v12, s[44:47], s11 offen offset:0 lds
    buffer_load_dwordx4 v13, s[44:47], s11 offen offset:1024 lds
    buffer_load_dwordx4 v14, s[44:47], s11 offen offset:2048 lds
    buffer_load_dwordx4 v15, s[44:47], s11 offen offset:3072 lds
    s_add_u32 s11, s11, 128
    s_add_u32 s84, s84, 32768
    s_cmp_eq_u32 s84, 131072
    s_cselect_b32 s84, 0, s84
    s_add_u32 m0, s84, s64
    s_nop 0
    buffer_load_dwordx4 v8, s[40:43], s11 offen offset:0 lds
    buffer_load_dwordx4 v9, s[40:43], s11 offen offset:1024 lds
    buffer_load_dwordx4 v10, s[40:43], s11 offen offset:2048 lds
    buffer_load_dwordx4 v11, s[40:43], s11 offen offset:3072 lds
    s_add_u32 m0, s84, s65
    s_nop 0
    buffer_load_dwordx4 v12, s[44:47], s11 offen offset:0 lds
    buffer_load_dwordx4 v13, s[44:47], s11 offen offset:1024 lds
    buffer_load_dwordx4 v14, s[44:47], s11 offen offset:2048 lds
    buffer_load_dwordx4 v15, s[44:47], s11 offen offset:3072 lds
    s_add_u32 s11, s11, 128
    s_add_u32 s84, s84, 32768
    s_cmp_eq_u32 s84, 131072
    s_cselect_b32 s84, 0, s84
    s_add_u32 m0, s84, s64
    s_nop 0
    buffer_load_dwordx4 v8, s[40:43], s11 offen offset:0 lds
    buffer_load_dwordx4 v9, s[40:43], s11 offen offset:1024 lds
    buffer_load_dwordx4 v10, s[40:43], s11 offen offset:2048 lds
    buffer_load_dwordx4 v11, s[40:43], s11 offen offset:3072 lds
    s_add_u32 m0, s84, s65
    s_nop 0
    buffer_load_dwordx4 v12, s[44:47], s11 offen offset:0 lds
    buffer_load_dwordx4 v13, s[44:47], s11 offen offset:1024 lds
    buffer_load_dwordx4 v14, s[44:47], s11 offen offset:2048 lds
    buffer_load_dwordx4 v15, s[44:47], s11 offen offset:3072 lds
    s_add_u32 s11, s11, 128
    s_add_u32 s84, s84, 32768
    s_cmp_eq_u32 s84, 131072
    s_cselect_b32 s84, 0, s84
    s_waitcnt vmcnt(16)
    s_barrier
    s_mov_b32 s85, 0
LLOOP_ab:
    v_add_u32 v49, s86, v48
    ds_read_b128 v[24:27], v49 offset:0
    ds_read_b128 v[28:31], v49 offset:1024
    ds_read_b128 v[32:35], v49 offset:2048
    ds_read_b128 v[36:39], v49 offset:3072
    s_waitcnt lgkmcnt(3)
    v_dot2_f32_bf16 v40, v24, s88, v40
    v_dot2_f32_bf16 v44, v24, v24, v44
    v_dot2_f32_bf16 v40, v25, s88, v40
    v_dot2_f32_bf16 v44, v25, v25, v44
    v_dot2_f32_bf16 v40, v26, s88, v40
    v_dot2_f32_bf16 v44, v26, v26, v44
    v_dot2_f32_bf16 v40, v27, s88, v40
    v_dot2_f32_bf16 v44, v27, v27, v44
    s_waitcnt lgkmcnt(2)
    v_dot2_f32_bf16 v41, v28, s88, v41
    v_dot2_f32_bf16 v45, v28, v28, v45
    v_dot2_f32_bf16 v41, v29, s88, v41
    v_dot2_f32_bf16 v45, v29, v29, v45
    v_dot2_f32_bf16 v41, v30, s88, v41
    v_dot2_f32_bf16 v45, v30, v30, v45
    v_dot2_f32_bf16 v41, v31, s88, v41
    v_dot2_f32_bf16 v45, v31, v31, v45
    s_waitcnt lgkmcnt(1)
    v_dot2_f32_bf16 v42, v32, s88, v42
    v_dot2_f32_bf16 v46, v32, v32, v46
    v_dot2_f32_bf16 v42, v33, s88, v42
    v_dot2_f32_bf16 v46, v33, v33, v46
    v_dot2_f32_bf16 v42, v34, s88, v42
    v_dot2_f32_bf16 v46, v34, v34, v46
    v_dot2_f32_bf16 v42, v35, s88, v42
    v_dot2_f32_bf16 v46, v35, v35, v46
    s_waitcnt lgkmcnt(0)
    v_dot2_f32_bf16 v43, v36, s88, v43
    v_dot2_f32_bf16 v47, v36, v36, v47
    v_dot2_f32_bf16 v43, v37, s88, v43
    v_dot2_f32_bf16 v47, v37, v37, v47
    v_dot2_f32_bf16 v43, v38, s88, v43
    v_dot2_f32_bf16 v47, v38, v38, v47
    v_dot2_f32_bf16 v43, v39, s88, v43
    v_dot2_f32_bf16 v47, v39, v39, v47
    s_add_u32 s86, s86, 32768
    s_cmp_eq_u32 s86, 131072
    s_cselect_b32 s86, 0, s86
    s_waitcnt vmcnt(8)
    s_barrier
    s_add_u32 m0, s84, s64
    s_nop 0
    buffer_load_dwordx4 v8, s[40:43], s11 offen offset:0 lds
    buffer_load_dwordx4 v9, s[40:43], s11 offen offset:1024 lds
    buffer_load_dwordx4 v10, s[40:43], s11 offen offset:2048 lds
    buffer_load_dwordx4 v11, s[40:43], s11 offen offset:3072 lds
    s_add_u32 m0, s84, s65
    s_nop 0
    buffer_load_dwordx4 v12, s[44:47], s11 offen offset:0 lds
    buffer_load_dwordx4 v13, s[44:47], s11 offen offset:1024 lds
    buffer_load_dwordx4 v14, s[44:47], s11 offen offset:2048 lds
    buffer_load_dwordx4 v15, s[44:47], s11 offen offset:3072 lds
    s_add_u32 s11, s11, 128
    s_add_u32 s84, s84, 32768
    s_cmp_eq_u32 s84, 131072
    s_cselect_b32 s84, 0, s84
    s_add_u32 s85, s85, 1
    s_cmp_lt_u32 s85, 5
    s_cbranch_scc1 LLOOP_ab
    v_add_u32 v49, s86, v48
    ds_read_b128 v[24:27], v49 offset:0
    ds_read_b128 v[28:31], v49 offset:1024
    ds_read_b128 v[32:35], v49 offset:2048
    ds_read_b128 v[36:39], v49 offset:3072
    s_waitcnt lgkmcnt(3)
    v_dot2_f32_bf16 v40, v24, s88, v40
    v_dot2_f32_bf16 v44, v24, v24, v44
    v_dot2_f32_bf16 v40, v25, s88, v40
    v_dot2_f32_bf16 v44, v25, v25, v44
    v_dot2_f32_bf16 v40, v26, s88, v40
    v_dot2_f32_bf16 v44, v26, v26, v44
    v_dot2_f32_bf16 v40, v27, s88, v40
    v_dot2_f32_bf16 v44, v27, v27, v44
    s_waitcnt lgkmcnt(2)
    v_dot2_f32_bf16 v41, v28, s88, v41
    v_dot2_f32_bf16 v45, v28, v28, v45
    v_dot2_f32_bf16 v41, v29, s88, v41
    v_dot2_f32_bf16 v45, v29, v29, v45
    v_dot2_f32_bf16 v41, v30, s88, v41
    v_dot2_f32_bf16 v45, v30, v30, v45
    v_dot2_f32_bf16 v41, v31, s88, v41
    v_dot2_f32_bf16 v45, v31, v31, v45
    s_waitcnt lgkmcnt(1)
    v_dot2_f32_bf16 v42, v32, s88, v42
    v_dot2_f32_bf16 v46, v32, v32, v46
    v_dot2_f32_bf16 v42, v33, s88, v42
    v_dot2_f32_bf16 v46, v33, v33, v46
    v_dot2_f32_bf16 v42, v34, s88, v42
    v_dot2_f32_bf16 v46, v34, v34, v46
    v_dot2_f32_bf16 v42, v35, s88, v42
    v_dot2_f32_bf16 v46, v35, v35, v46
    s_waitcnt lgkmcnt(0)
    v_dot2_f32_bf16 v43, v36, s88, v43
    v_dot2_f32_bf16 v47, v36, v36, v47
    v_dot2_f32_bf16 v43, v37, s88, v43
    v_dot2_f32_bf16 v47, v37, v37, v47
    v_dot2_f32_bf16 v43, v38, s88, v43
    v_dot2_f32_bf16 v47, v38, v38, v47
    v_dot2_f32_bf16 v43, v39, s88, v43
    v_dot2_f32_bf16 v47, v39, v39, v47
    s_add_u32 s86, s86, 32768
    s_cmp_eq_u32 s86, 131072
    s_cselect_b32 s86, 0, s86
    s_waitcnt vmcnt(8)
    s_barrier
    v_add_u32 v49, s86, v48
    ds_read_b128 v[24:27], v49 offset:0
    ds_read_b128 v[28:31], v49 offset:1024
    ds_read_b128 v[32:35], v49 offset:2048
    ds_read_b128 v[36:39], v49 offset:3072
    s_waitcnt lgkmcnt(3)
    v_dot2_f32_bf16 v40, v24, s88, v40
    v_dot2_f32_bf16 v44, v24, v24, v44
    v_dot2_f32_bf16 v40, v25, s88, v40
    v_dot2_f32_bf16 v44, v25, v25, v44
    v_dot2_f32_bf16 v40, v26, s88, v40
    v_dot2_f32_bf16 v44, v26, v26, v44
    v_dot2_f32_bf16 v40, v27, s88, v40
    v_dot2_f32_bf16 v44, v27, v27, v44
    s_waitcnt lgkmcnt(2)
    v_dot2_f32_bf16 v41, v28, s88, v41
    v_dot2_f32_bf16 v45, v28, v28, v45
    v_dot2_f32_bf16 v41, v29, s88, v41
    v_dot2_f32_bf16 v45, v29, v29, v45
    v_dot2_f32_bf16 v41, v30, s88, v41
    v_dot2_f32_bf16 v45, v30, v30, v45
    v_dot2_f32_bf16 v41, v31, s88, v41
    v_dot2_f32_bf16 v45, v31, v31, v45
    s_waitcnt lgkmcnt(1)
    v_dot2_f32_bf16 v42, v32, s88, v42
    v_dot2_f32_bf16 v46, v32, v32, v46
    v_dot2_f32_bf16 v42, v33, s88, v42
    v_dot2_f32_bf16 v46, v33, v33, v46
    v_dot2_f32_bf16 v42, v34, s88, v42
    v_dot2_f32_bf16 v46, v34, v34, v46
    v_dot2_f32_bf16 v42, v35, s88, v42
    v_dot2_f32_bf16 v46, v35, v35, v46
    s_waitcnt lgkmcnt(0)
    v_dot2_f32_bf16 v43, v36, s88, v43
    v_dot2_f32_bf16 v47, v36, v36, v47
    v_dot2_f32_bf16 v43, v37, s88, v43
    v_dot2_f32_bf16 v47, v37, v37, v47
    v_dot2_f32_bf16 v43, v38, s88, v43
    v_dot2_f32_bf16 v47, v38, v38, v47
    v_dot2_f32_bf16 v43, v39, s88, v43
    v_dot2_f32_bf16 v47, v39, v39, v47
    s_add_u32 s86, s86, 32768
    s_cmp_eq_u32 s86, 131072
    s_cselect_b32 s86, 0, s86
    s_waitcnt vmcnt(0)
    s_barrier
    v_add_u32 v49, s86, v48
    ds_read_b128 v[24:27], v49 offset:0
    ds_read_b128 v[28:31], v49 offset:1024
    ds_read_b128 v[32:35], v49 offset:2048
    ds_read_b128 v[36:39], v49 offset:3072
    s_waitcnt lgkmcnt(3)
    v_dot2_f32_bf16 v40, v24, s88, v40
    v_dot2_f32_bf16 v44, v24, v24, v44
    v_dot2_f32_bf16 v40, v25, s88, v40
    v_dot2_f32_bf16 v44, v25, v25, v44
    v_dot2_f32_bf16 v40, v26, s88, v40
    v_dot2_f32_bf16 v44, v26, v26, v44
    v_dot2_f32_bf16 v40, v27, s88, v40
    v_dot2_f32_bf16 v44, v27, v27, v44
    s_waitcnt lgkmcnt(2)
    v_dot2_f32_bf16 v41, v28, s88, v41
    v_dot2_f32_bf16 v45, v28, v28, v45
    v_dot2_f32_bf16 v41, v29, s88, v41
    v_dot2_f32_bf16 v45, v29, v29, v45
    v_dot2_f32_bf16 v41, v30, s88, v41
    v_dot2_f32_bf16 v45, v30, v30, v45
    v_dot2_f32_bf16 v41, v31, s88, v41
    v_dot2_f32_bf16 v45, v31, v31, v45
    s_waitcnt lgkmcnt(1)
    v_dot2_f32_bf16 v42, v32, s88, v42
    v_dot2_f32_bf16 v46, v32, v32, v46
    v_dot2_f32_bf16 v42, v33, s88, v42
    v_dot2_f32_bf16 v46, v33, v33, v46
    v_dot2_f32_bf16 v42, v34, s88, v42
    v_dot2_f32_bf16 v46, v34, v34, v46
    v_dot2_f32_bf16 v42, v35, s88, v42
    v_dot2_f32_bf16 v46, v35, v35, v46
    s_waitcnt lgkmcnt(0)
    v_dot2_f32_bf16 v43, v36, s88, v43
    v_dot2_f32_bf16 v47, v36, v36, v47
    v_dot2_f32_bf16 v43, v37, s88, v43
    v_dot2_f32_bf16 v47, v37, v37, v47
    v_dot2_f32_bf16 v43, v38, s88, v43
    v_dot2_f32_bf16 v47, v38, v38, v47
    v_dot2_f32_bf16 v43, v39, s88, v43
    v_dot2_f32_bf16 v47, v39, v39, v47
    s_add_u32 s86, s86, 32768
    s_cmp_eq_u32 s86, 131072
    s_cselect_b32 s86, 0, s86
    s_waitcnt vmcnt(0)
    s_barrier
    v_add_f32_dpp v24, v40, v40 quad_perm:[1,0,3,2] row_mask:0xf bank_mask:0xf
    v_add_f32_dpp v25, v41, v41 quad_perm:[1,0,3,2] row_mask:0xf bank_mask:0xf
    v_add_f32_dpp v26, v42, v42 quad_perm:[1,0,3,2] row_mask:0xf bank_mask:0xf
    v_add_f32_dpp v27, v43, v43 quad_perm:[1,0,3,2] row_mask:0xf bank_mask:0xf
    v_add_f32_dpp v28, v44, v44 quad_perm:[1,0,3,2] row_mask:0xf bank_mask:0xf
    v_add_f32_dpp v29, v45, v45 quad_perm:[1,0,3,2] row_mask:0xf bank_mask:0xf
    v_add_f32_dpp v30, v46, v46 quad_perm:[1,0,3,2] row_mask:0xf bank_mask:0xf
    v_add_f32_dpp v31, v47, v47 quad_perm:[1,0,3,2] row_mask:0xf bank_mask:0xf
    s_nop 1
    v_mov_b32 v40, v24
    v_mov_b32 v41, v25
    v_mov_b32 v42, v26
    v_mov_b32 v43, v27
    v_mov_b32 v44, v28
    v_mov_b32 v45, v29
    v_mov_b32 v46, v30
    v_mov_b32 v47, v31
    s_nop 1
    v_add_f32_dpp v24, v40, v40 quad_perm:[2,3,0,1] row_mask:0xf bank_mask:0xf
    v_add_f32_dpp v25, v41, v41 quad_perm:[2,3,0,1] row_mask:0xf bank_mask:0xf
    v_add_f32_dpp v26, v42, v42 quad_perm:[2,3,0,1] row_mask:0xf bank_mask:0xf
    v_add_f32_dpp v27, v43, v43 quad_perm:[2,3,0,1] row_mask:0xf bank_mask:0xf
    v_add_f32_dpp v28, v44, v44 quad_perm:[2,3,0,1] row_mask:0xf bank_mask:0xf
    v_add_f32_dpp v29, v45, v45 quad_perm:[2,3,0,1] row_mask:0xf bank_mask:0xf
    v_add_f32_dpp v30, v46, v46 quad_perm:[2,3,0,1] row_mask:0xf bank_mask:0xf
    v_add_f32_dpp v31, v47, v47 quad_perm:[2,3,0,1] row_mask:0xf bank_mask:0xf
    s_nop 1
    v_mov_b32 v40, v24
    v_mov_b32 v41, v25
    v_mov_b32 v42, v26
    v_mov_b32 v43, v27
    v_mov_b32 v44, v28
    v_mov_b32 v45, v29
    v_mov_b32 v46, v30
    v_mov_b32 v47, v31
    s_nop 1
    v_add_f32_dpp v24, v40, v40 row_half_mirror row_mask:0xf bank_mask:0xf
    v_add_f32_dpp v25, v41, v41 row_half_mirror row_mask:0xf bank_mask:0xf
    v_add_f32_dpp v26, v42, v42 row_half_mirror row_mask:0xf bank_mask:0xf
    v_add_f32_dpp v27, v43, v43 row_half_mirror row_mask:0xf bank_mask:0xf
    v_add_f32_dpp v28, v44, v44 row_half_mirror row_mask:0xf bank_mask:0xf
    v_add_f32_dpp v29, v45, v45 row_half_mirror row_mask:0xf bank_mask:0xf
    v_add_f32_dpp v30, v46, v46 row_half_mirror row_mask:0xf bank_mask:0xf
    v_add_f32_dpp v31, v47, v47 row_half_mirror row_mask:0xf bank_mask:0xf
    s_nop 1
    v_mov_b32 v40, v24
    v_mov_b32 v41, v25
    v_mov_b32 v42, v26
    v_mov_b32 v43, v27
    v_mov_b32 v44, v28
    v_mov_b32 v45, v29
    v_mov_b32 v46, v30
    v_mov_b32 v47, v31
    s_nop 1
    v_lshrrev_b32 v49, 3, v2
    s_lshl_b32 s63, s87, 5
    v_add_u32 v49, s63, v49
    v_lshlrev_b32 v49, 2, v49
    v_add_u32 v49, 135168, v49
    v_mul_f32 v40, 0x3b000000, v40
    v_mul_f32 v44, 0x3b000000, v44
    v_fma_f32 v44, -v40, v40, v44
    v_max_f32 v44, 0, v44
    v_add_f32 v44, 0x3727c5ac, v44
    v_rsq_f32 v44, v44
    v_mul_f32 v40, -1.0, v40
    v_mul_f32 v41, 0x3b000000, v41
    v_mul_f32 v45, 0x3b000000, v45
    v_fma_f32 v45, -v41, v41, v45
    v_max_f32 v45, 0, v45
    v_add_f32 v45, 0x3727c5ac, v45
    v_rsq_f32 v45, v45
    v_mul_f32 v41, -1.0, v41
    v_mul_f32 v42, 0x3b000000, v42
    v_mul_f32 v46, 0x3b000000, v46
    v_fma_f32 v46, -v42, v42, v46
    v_max_f32 v46, 0, v46
    v_add_f32 v46, 0x3727c5ac, v46
    v_rsq_f32 v46, v46
    v_mul_f32 v42, -1.0, v42
    v_mul_f32 v43, 0x3b000000, v43
    v_mul_f32 v47, 0x3b000000, v47
    v_fma_f32 v47, -v43, v43, v47
    v_max_f32 v47, 0, v47
    v_add_f32 v47, 0x3727c5ac, v47
    v_rsq_f32 v47, v47
    v_mul_f32 v43, -1.0, v43
    s_nop 1
    ds_write_b32 v49, v44 offset:0
    ds_write_b32 v49, v40 offset:512
    ds_write_b32 v49, v45 offset:32
    ds_write_b32 v49, v41 offset:544
    ds_write_b32 v49, v46 offset:64
    ds_write_b32 v49, v42 offset:576
    ds_write_b32 v49, v47 offset:96
    ds_write_b32 v49, v43 offset:608
    s_waitcnt lgkmcnt(0)
    s_barrier
    s_barrier
    s_barrier
    s_cmp_lg_u32 s60, 5
    s_cbranch_scc1 DFS_7
    s_lshr_b32 s72, s7, 2
    s_lshl_b32 s72, s72, 5
    s_lshl_b32 s73, s6, 1
    s_add_u32 s72, s72, s73
    s_cmp_ge_u32 s72, 50
    s_cbranch_scc1 DFS_7
    s_cmp_ge_u32 s72, 25
    s_cselect_b32 s73, 1, 0
    s_add_u32 s74, s72, 1
    s_cmp_ge_u32 s74, 25
    s_cselect_b32 s74, 1, 0
    s_sub_u32 s74, s74, s73
    s_and_b32 s75, s7, 3
    s_lshr_b32 s72, s72, 1
    s_add_u32 s56, s36, 0x1e08000
    s_addc_u32 s57, s37, 0
    s_mov_b32 s58, 0x8000
    s_mov_b32 s59, 0x00020000
    v_and_b32 v250, 15, v0
    v_lshrrev_b32 v251, 4, v0
    v_and_b32 v251, s74, v251
    v_add_u32 v251, s73, v251
    v_lshrrev_b32 v252, 2, v250
    v_lshl_add_u32 v252, v251, 2, v252
    v_and_b32 v253, 3, v250
    v_lshlrev_b32 v253, 2, v253
    v_add_u32 v253, s75, v253
    v_and_b32 v254, 1, v253
    v_lshrrev_b32 v253, 1, v253
    v_lshl_add_u32 v253, v253, 2, v254
    v_lshl_add_u32 v252, v253, 3, v252
    v_mul_u32_u24 v251, 25, v251
    v_lshrrev_b32 v251, 1, v251
    v_sub_u32 v251, s72, v251
    v_lshlrev_b32 v252, 7, v252
    v_lshl_add_u32 v252, v251, 2, v252
    v_mov_b32 v253, 1
    s_mov_b32 exec_lo, -1
    s_mov_b32 exec_hi, 0
    buffer_store_dword v253, v252, s[56:59], 0 offen offset:64 sc0 sc1
    s_mov_b64 exec, -1
DFS_7:
    s_cmp_lg_u32 s60, 4
    s_cbranch_scc1 P1D_8
    s_mov_b32 s4, s34
    s_mov_b32 s5, s35
    s_mov_b32 s6, 0x100
    s_mov_b32 s7, 0x00020000
    s_mov_b64 exec, 1
    v_mov_b32 v254, 0
    v_mov_b32 v255, 0x10001
    buffer_atomic_add v255, v254, s[4:7], 0 offen sc0 sc1
    s_waitcnt vmcnt(0)
    v_readfirstlane_b32 s14, v255
    s_mov_b64 exec, -1
    s_mov_b32 s59, s14
    s_add_u32 s4, s36, 0x1e08000
    s_addc_u32 s5, s37, 0
    s_mov_b32 s6, 0x8000
    s_mov_b32 s7, 0x00020000
    v_and_b32 v253, 63, v0
    v_and_b32 v254, 15, v253
    v_lshrrev_b32 v255, 4, v253
    v_lshl_add_u32 v254, v255, 5, v254
    v_lshlrev_b32 v254, 7, v254
    v_mov_b32 v255, 1
    s_and_b32 s15, s14, 0xffff
    s_cmpk_lg_u32 s15, 127
    s_cbranch_scc1 P1E_8
    buffer_store_dword v255, v254, s[4:7], 0 offen sc0 sc1
    s_movk_i32 s15, 0x4000
    buffer_store_dword v255, v254, s[4:7], s15 offen sc0 sc1
P1E_8:
    s_lshr_b32 s15, s14, 16
    s_cmpk_lg_u32 s15, 255
    s_cbranch_scc1 P1D_8
    s_movk_i32 s15, 0x800
    buffer_store_dword v255, v254, s[4:7], s15 offen sc0 sc1
    s_movk_i32 s15, 0x4800
    buffer_store_dword v255, v254, s[4:7], s15 offen sc0 sc1
P1D_8:
    s_branch P2_LD
K1_AB_CMP:
    s_add_u32 s48, s36, 0x400000
    s_addc_u32 s49, s37, 0
    s_mov_b32 s50, 0x5c0000
    s_mov_b32 s51, 0x00020000
    s_mul_i32 s9, s13, 1507328
    s_add_u32 s9, s9, s71
    s_lshl_b32 s10, s6, 8
    s_add_u32 s9, s9, s10
    s_cmpk_ge_u32 s2, 224
    s_cbranch_scc1 PRE_A9
    s_mov_b32 s72, s30
    s_mov_b32 s73, s31
    s_mov_b32 s74, 0x1c0000
    s_mov_b32 s75, 0x00020000
    s_lshr_b32 s4, s2, 3
    s_and_b32 s5, s2, 7
    s_lshl_b32 s8, s4, 16
    s_lshl_b32 s12, s5, 7
    s_add_u32 s8, s8, s12
    s_mul_i32 s58, s5, 753664
    s_lshl_b32 s12, s4, 7
    s_add_u32 s58, s58, s12
    v_lshrrev_b32 v120, 3, v0
    v_and_b32 v121, 7, v0
    v_lshlrev_b32 v122, 10, v120
    v_lshl_add_u32 v122, v121, 4, v122
    v_add_u32 v123, 0x8000, v122
    buffer_load_dwordx4 v[100:103], v122, s[72:75], s8 offen
    buffer_load_dwordx4 v[104:107], v123, s[72:75], s8 offen
PRE_A9:
    v_and_b32 v132, 63, v0
    v_and_b32 v133, 15, v132
    v_lshrrev_b32 v134, 4, v132
    v_and_b32 v135, 7, v132
    v_xor_b32 v134, v134, v135
    v_lshlrev_b32 v134, 4, v134
    v_lshl_add_u32 v134, v133, 7, v134
    s_lshr_b32 s66, s87, 1
    s_and_b32 s67, s87, 1
    s_mul_i32 s68, s66, 8192
    s_lshl_b32 s69, s67, 13
    s_add_u32 s69, s69, 16384
    v_add_u32 v156, s68, v134
    v_add_u32 v158, s69, v134
    v_add_u32 v160, s68, v134
    v_xor_b32 v160, 64, v160
    v_add_u32 v162, s69, v134
    v_xor_b32 v162, 64, v162
    v_mov_b32 v136, 0
    v_mov_b32 v137, 0
    v_mov_b32 v138, 0
    v_mov_b32 v139, 0
    v_mov_b32 v140, 0
    v_mov_b32 v141, 0
    v_mov_b32 v142, 0
    v_mov_b32 v143, 0
    v_mov_b32 v144, 0
    v_mov_b32 v145, 0
    v_mov_b32 v146, 0
    v_mov_b32 v147, 0
    v_mov_b32 v148, 0
    v_mov_b32 v149, 0
    v_mov_b32 v150, 0
    v_mov_b32 v151, 0
    v_mov_b32 v152, 0x3f803f80
    v_mov_b32 v153, 0x3f803f80
    v_mov_b32 v154, 0x3f803f80
    v_mov_b32 v155, 0x3f803f80
    v_mov_b32 v4, 0
    v_mov_b32 v5, 0
    v_mov_b32 v6, 0
    v_mov_b32 v7, 0
    v_mov_b32 v8, 0
    v_mov_b32 v9, 0
    v_mov_b32 v10, 0
    v_mov_b32 v11, 0
    v_mov_b32 v12, 0
    v_mov_b32 v13, 0
    v_mov_b32 v14, 0
    v_mov_b32 v15, 0
    v_mov_b32 v16, 0
    v_mov_b32 v17, 0
    v_mov_b32 v18, 0
    v_mov_b32 v19, 0
    v_mov_b32 v20, 0
    v_mov_b32 v21, 0
    v_mov_b32 v22, 0
    v_mov_b32 v23, 0
    v_mov_b32 v24, 0
    v_mov_b32 v25, 0
    v_mov_b32 v26, 0
    v_mov_b32 v27, 0
    v_mov_b32 v28, 0
    v_mov_b32 v29, 0
    v_mov_b32 v30, 0
    v_mov_b32 v31, 0
    v_mov_b32 v32, 0
    v_mov_b32 v33, 0
    v_mov_b32 v34, 0
    v_mov_b32 v35, 0
    v_mov_b32 v36, 0
    v_mov_b32 v37, 0
    v_mov_b32 v38, 0
    v_mov_b32 v39, 0
    v_mov_b32 v40, 0
    v_mov_b32 v41, 0
    v_mov_b32 v42, 0
    v_mov_b32 v43, 0
    v_mov_b32 v44, 0
    v_mov_b32 v45, 0
    v_mov_b32 v46, 0
    v_mov_b32 v47, 0
    v_mov_b32 v48, 0
    v_mov_b32 v49, 0
    v_mov_b32 v50, 0
    v_mov_b32 v51, 0
    v_mov_b32 v52, 0
    v_mov_b32 v53, 0
    v_mov_b32 v54, 0
    v_mov_b32 v55, 0
    v_mov_b32 v56, 0
    v_mov_b32 v57, 0
    v_mov_b32 v58, 0
    v_mov_b32 v59, 0
    v_mov_b32 v60, 0
    v_mov_b32 v61, 0
    v_mov_b32 v62, 0
    v_mov_b32 v63, 0
    v_mov_b32 v64, 0
    v_mov_b32 v65, 0
    v_mov_b32 v66, 0
    v_mov_b32 v67, 0
    s_mov_b32 s82, 0
    s_mov_b32 s83, 32768
    s_mov_b32 s85, 0
    s_cmpk_ge_u32 s2, 224
    s_cbranch_scc1 PRE_B10
    v_mul_u32_u24 v122, 144, v120
    v_lshl_add_u32 v122, v121, 4, v122
    v_add_u32 v122, 137216, v122
    s_waitcnt vmcnt(0)
    ds_write_b128 v122, v[100:103]
    ds_write_b128 v122, v[104:107] offset:4608
PRE_B10:
    s_cmp_lg_u32 s60, 0
    s_cbranch_scc1 PRE_F10
    s_add_u32 s72, s36, 0x1e08000
    s_addc_u32 s73, s37, 0
    s_mov_b32 s74, 0x8000
    s_mov_b32 s75, 0x00020000
    s_lshl_b32 s12, s2, 7
    v_mov_b32 v122, s12
    v_mov_b32 v123, 0
    v_lshl_add_u32 v122, v0, 2, v122
    s_mov_b32 exec_lo, -1
    s_mov_b32 exec_hi, 0
    buffer_store_dword v123, v122, s[72:75], 0 offen sc0 sc1
    s_mov_b64 exec, -1
PRE_F10:
    s_cmpk_lg_u32 s2, 0
    s_cbranch_scc1 PRE_C10
    s_add_u32 s72, s36, 0x1e00000
    s_addc_u32 s73, s37, 0
    s_mov_b32 s74, 0x8000
    s_mov_b32 s75, 0x00020000
    v_lshlrev_b32 v122, 4, v0
    v_mov_b32 v100, 0
    v_mov_b32 v101, 0
    v_mov_b32 v102, 0
    v_mov_b32 v103, 0
    s_mov_b32 s12, 0
    buffer_store_dwordx4 v[100:103], v122, s[72:75], s12 offen sc0 sc1
    s_add_u32 s12, s12, 4096
    buffer_store_dwordx4 v[100:103], v122, s[72:75], s12 offen sc0 sc1
    s_add_u32 s12, s12, 4096
    buffer_store_dwordx4 v[100:103], v122, s[72:75], s12 offen sc0 sc1
    s_add_u32 s12, s12, 4096
    buffer_store_dwordx4 v[100:103], v122, s[72:75], s12 offen sc0 sc1
    s_add_u32 s12, s12, 4096
    buffer_store_dwordx4 v[100:103], v122, s[72:75], s12 offen sc0 sc1
    s_add_u32 s12, s12, 4096
    buffer_store_dwordx4 v[100:103], v122, s[72:75], s12 offen sc0 sc1
    s_add_u32 s12, s12, 4096
    buffer_store_dwordx4 v[100:103], v122, s[72:75], s12 offen sc0 sc1
    s_add_u32 s12, s12, 4096
    buffer_store_dwordx4 v[100:103], v122, s[72:75], s12 offen sc0 sc1
    s_add_u32 s12, s12, 4096
PRE_C10:
    s_waitcnt lgkmcnt(0)
    s_barrier
    v_add_u32 v157, s82, v156
    v_add_u32 v159, s82, v158
    ds_read_b128 v[68:71], v157 offset:0
    ds_read_b128 v[84:87], v159 offset:0
    ds_read_b128 v[88:91], v159 offset:2048
    ds_read_b128 v[92:95], v159 offset:4096
    ds_read_b128 v[96:99], v159 offset:6144
    ds_read_b128 v[72:75], v157 offset:2048
    ds_read_b128 v[76:79], v157 offset:4096
    ds_read_b128 v[80:83], v157 offset:6144
    s_cmpk_ge_u32 s2, 224
    s_cbranch_scc1 POST_A11
    s_add_u32 s72, s36, 0x402000
    s_addc_u32 s73, s37, 0
    s_mov_b32 s74, 0x5be000
    s_mov_b32 s75, 0x00020000
    v_mul_u32_u24 v122, 1152, v121
    v_lshl_add_u32 v122, v120, 1, v122
    v_add_u32 v122, 137216, v122
    ds_read_u16 v100, v122 offset:0
    ds_read_u16 v108, v122 offset:144
    ds_read_u16 v101, v122 offset:288
    ds_read_u16 v109, v122 offset:432
    ds_read_u16 v102, v122 offset:576
    ds_read_u16 v110, v122 offset:720
    ds_read_u16 v103, v122 offset:864
    ds_read_u16 v111, v122 offset:1008
    ds_read_u16 v104, v122 offset:64
    ds_read_u16 v112, v122 offset:208
    ds_read_u16 v105, v122 offset:352
    ds_read_u16 v113, v122 offset:496
    ds_read_u16 v106, v122 offset:640
    ds_read_u16 v114, v122 offset:784
    ds_read_u16 v107, v122 offset:928
    ds_read_u16 v115, v122 offset:1072
    s_mov_b32 s12, 11776
    v_mul_lo_u32 v123, v120, s12
    v_lshl_add_u32 v123, v121, 4, v123
    v_add_u32 v122, 376832, v123
    s_waitcnt lgkmcnt(0)
    v_lshl_or_b32 v100, v108, 16, v100
    v_lshl_or_b32 v101, v109, 16, v101
    v_lshl_or_b32 v102, v110, 16, v102
    v_lshl_or_b32 v103, v111, 16, v103
    v_lshl_or_b32 v104, v112, 16, v104
    v_lshl_or_b32 v105, v113, 16, v105
    v_lshl_or_b32 v106, v114, 16, v106
    v_lshl_or_b32 v107, v115, 16, v107
    buffer_store_dwordx4 v[100:103], v123, s[72:75], s58 offen sc0 sc1
    buffer_store_dwordx4 v[104:107], v122, s[72:75], s58 offen sc0 sc1
POST_A11:
    v_add_u32 v161, s82, v160
    v_add_u32 v163, s82, v162
LOOP_ab:
    s_waitcnt lgkmcnt(3)
    v_mfma_f32_16x16x32_bf16 v[4:7], v[68:71], v[84:87], v[4:7]
    ds_read_b128 v[100:103], v161 offset:0
    v_mfma_f32_16x16x32_bf16 v[8:11], v[68:71], v[88:91], v[8:11]
    ds_read_b128 v[116:119], v163 offset:0
    v_mfma_f32_16x16x32_bf16 v[12:15], v[68:71], v[92:95], v[12:15]
    ds_read_b128 v[120:123], v163 offset:2048
    v_mfma_f32_16x16x32_bf16 v[16:19], v[68:71], v[96:99], v[16:19]
    ds_read_b128 v[124:127], v163 offset:4096
    s_waitcnt lgkmcnt(6)
    v_mfma_f32_16x16x32_bf16 v[20:23], v[72:75], v[84:87], v[20:23]
    ds_read_b128 v[128:131], v163 offset:6144
    v_mfma_f32_16x16x32_bf16 v[24:27], v[72:75], v[88:91], v[24:27]
    ds_read_b128 v[104:107], v161 offset:2048
    v_mfma_f32_16x16x32_bf16 v[28:31], v[72:75], v[92:95], v[28:31]
    ds_read_b128 v[108:111], v161 offset:4096
    v_mfma_f32_16x16x32_bf16 v[32:35], v[72:75], v[96:99], v[32:35]
    ds_read_b128 v[112:115], v161 offset:6144
    s_waitcnt lgkmcnt(9)
    v_mfma_f32_16x16x32_bf16 v[36:39], v[76:79], v[84:87], v[36:39]
    v_add_u32 v157, s83, v156
    v_mfma_f32_16x16x32_bf16 v[40:43], v[76:79], v[88:91], v[40:43]
    v_add_u32 v159, s83, v158
    v_mfma_f32_16x16x32_bf16 v[44:47], v[76:79], v[92:95], v[44:47]
    v_mfma_f32_16x16x32_bf16 v[48:51], v[76:79], v[96:99], v[48:51]
    s_waitcnt lgkmcnt(8)
    v_mfma_f32_16x16x32_bf16 v[52:55], v[80:83], v[84:87], v[52:55]
    v_mfma_f32_16x16x32_bf16 v[56:59], v[80:83], v[88:91], v[56:59]
    v_mfma_f32_16x16x32_bf16 v[60:63], v[80:83], v[92:95], v[60:63]
    v_mfma_f32_16x16x32_bf16 v[64:67], v[80:83], v[96:99], v[64:67]
    v_mfma_f32_16x16x32_bf16 v[136:139], v[152:155], v[84:87], v[136:139]
    v_mfma_f32_16x16x32_bf16 v[140:143], v[152:155], v[88:91], v[140:143]
    v_mfma_f32_16x16x32_bf16 v[144:147], v[152:155], v[92:95], v[144:147]
    v_mfma_f32_16x16x32_bf16 v[148:151], v[152:155], v[96:99], v[148:151]
    s_barrier
    s_waitcnt lgkmcnt(3)
    v_mfma_f32_16x16x32_bf16 v[4:7], v[100:103], v[116:119], v[4:7]
    ds_read_b128 v[68:71], v157 offset:0
    v_mfma_f32_16x16x32_bf16 v[8:11], v[100:103], v[120:123], v[8:11]
    ds_read_b128 v[84:87], v159 offset:0
    v_mfma_f32_16x16x32_bf16 v[12:15], v[100:103], v[124:127], v[12:15]
    ds_read_b128 v[88:91], v159 offset:2048
    v_mfma_f32_16x16x32_bf16 v[16:19], v[100:103], v[128:131], v[16:19]
    ds_read_b128 v[92:95], v159 offset:4096
    s_waitcnt lgkmcnt(6)
    v_mfma_f32_16x16x32_bf16 v[20:23], v[104:107], v[116:119], v[20:23]
    ds_read_b128 v[96:99], v159 offset:6144
    v_mfma_f32_16x16x32_bf16 v[24:27], v[104:107], v[120:123], v[24:27]
    ds_read_b128 v[72:75], v157 offset:2048
    v_mfma_f32_16x16x32_bf16 v[28:31], v[104:107], v[124:127], v[28:31]
    ds_read_b128 v[76:79], v157 offset:4096
    v_mfma_f32_16x16x32_bf16 v[32:35], v[104:107], v[128:131], v[32:35]
    ds_read_b128 v[80:83], v157 offset:6144
    s_waitcnt lgkmcnt(9)
    v_mfma_f32_16x16x32_bf16 v[36:39], v[108:111], v[116:119], v[36:39]
    v_add_u32 v161, s83, v160
    v_mfma_f32_16x16x32_bf16 v[40:43], v[108:111], v[120:123], v[40:43]
    v_add_u32 v163, s83, v162
    v_mfma_f32_16x16x32_bf16 v[44:47], v[108:111], v[124:127], v[44:47]
    s_mov_b32 s82, s83
    v_mfma_f32_16x16x32_bf16 v[48:51], v[108:111], v[128:131], v[48:51]
    s_add_u32 s83, s83, 32768
    s_waitcnt lgkmcnt(8)
    v_mfma_f32_16x16x32_bf16 v[52:55], v[112:115], v[116:119], v[52:55]
    s_cmp_eq_u32 s83, 131072
    v_mfma_f32_16x16x32_bf16 v[56:59], v[112:115], v[120:123], v[56:59]
    s_cselect_b32 s83, 0, s83
    v_mfma_f32_16x16x32_bf16 v[60:63], v[112:115], v[124:127], v[60:63]
    s_add_u32 s85, s85, 1
    v_mfma_f32_16x16x32_bf16 v[64:67], v[112:115], v[128:131], v[64:67]
    v_mfma_f32_16x16x32_bf16 v[136:139], v[152:155], v[116:119], v[136:139]
    v_mfma_f32_16x16x32_bf16 v[140:143], v[152:155], v[120:123], v[140:143]
    v_mfma_f32_16x16x32_bf16 v[144:147], v[152:155], v[124:127], v[144:147]
    v_mfma_f32_16x16x32_bf16 v[148:151], v[152:155], v[128:131], v[148:151]
    s_cmp_lt_u32 s85, 8
    s_cbranch_scc1 LOOP_ab
    s_waitcnt lgkmcnt(0)
    s_nop 7
    s_nop 7
EPI_ab:
    v_and_b32 v132, 63, v0
    v_and_b32 v133, 15, v132
    v_lshrrev_b32 v134, 4, v132
    s_barrier
    s_lshl_b32 s64, s66, 8
    s_add_u32 s64, s64, 135168
    v_lshlrev_b32 v135, 4, v134
    v_add_u32 v135, s64, v135
    ds_read_b128 v[68:71], v135 offset:0
    ds_read_b128 v[100:103], v135 offset:512
    ds_read_b128 v[72:75], v135 offset:64
    ds_read_b128 v[104:107], v135 offset:576
    ds_read_b128 v[76:79], v135 offset:128
    ds_read_b128 v[108:111], v135 offset:640
    ds_read_b128 v[80:83], v135 offset:192
    ds_read_b128 v[112:115], v135 offset:704
    s_lshl_b32 s63, s67, 6
    v_add_u32 v133, s63, v133
    v_mul_u32_u24 v133, 272, v133
    v_lshl_add_u32 v133, v134, 3, v133
    s_mul_i32 s63, s66, 128
    v_add_u32 v133, s63, v133
    s_waitcnt lgkmcnt(0)
    v_mul_f32 v68, s70, v68
    v_mul_f32 v69, s70, v69
    v_mul_f32 v70, s70, v70
    v_mul_f32 v71, s70, v71
    v_mul_f32 v72, s70, v72
    v_mul_f32 v73, s70, v73
    v_mul_f32 v74, s70, v74
    v_mul_f32 v75, s70, v75
    v_mul_f32 v76, s70, v76
    v_mul_f32 v77, s70, v77
    v_mul_f32 v78, s70, v78
    v_mul_f32 v79, s70, v79
    v_mul_f32 v80, s70, v80
    v_mul_f32 v81, s70, v81
    v_mul_f32 v82, s70, v82
    v_mul_f32 v83, s70, v83
    v_pk_fma_f32 v[4:5], v[100:101], v[136:137], v[4:5] op_sel_hi:[1,0,1]
    v_pk_mul_f32 v[4:5], v[4:5], v[68:69]
    v_pk_fma_f32 v[6:7], v[102:103], v[136:137], v[6:7] op_sel_hi:[1,0,1]
    v_pk_mul_f32 v[6:7], v[6:7], v[70:71]
    v_cvt_pk_bf16_f32 v164, v4, v5
    v_cvt_pk_bf16_f32 v165, v6, v7
    ds_write_b64 v133, v[164:165] offset:0
    v_pk_fma_f32 v[8:9], v[100:101], v[140:141], v[8:9] op_sel_hi:[1,0,1]
    v_pk_mul_f32 v[8:9], v[8:9], v[68:69]
    v_pk_fma_f32 v[10:11], v[102:103], v[140:141], v[10:11] op_sel_hi:[1,0,1]
    v_pk_mul_f32 v[10:11], v[10:11], v[70:71]
    v_cvt_pk_bf16_f32 v164, v8, v9
    v_cvt_pk_bf16_f32 v165, v10, v11
    ds_write_b64 v133, v[164:165] offset:4352
    v_pk_fma_f32 v[12:13], v[100:101], v[144:145], v[12:13] op_sel_hi:[1,0,1]
    v_pk_mul_f32 v[12:13], v[12:13], v[68:69]
    v_pk_fma_f32 v[14:15], v[102:103], v[144:145], v[14:15] op_sel_hi:[1,0,1]
    v_pk_mul_f32 v[14:15], v[14:15], v[70:71]
    v_cvt_pk_bf16_f32 v164, v12, v13
    v_cvt_pk_bf16_f32 v165, v14, v15
    ds_write_b64 v133, v[164:165] offset:8704
    v_pk_fma_f32 v[16:17], v[100:101], v[148:149], v[16:17] op_sel_hi:[1,0,1]
    v_pk_mul_f32 v[16:17], v[16:17], v[68:69]
    v_pk_fma_f32 v[18:19], v[102:103], v[148:149], v[18:19] op_sel_hi:[1,0,1]
    v_pk_mul_f32 v[18:19], v[18:19], v[70:71]
    v_cvt_pk_bf16_f32 v164, v16, v17
    v_cvt_pk_bf16_f32 v165, v18, v19
    ds_write_b64 v133, v[164:165] offset:13056
    v_pk_fma_f32 v[20:21], v[104:105], v[136:137], v[20:21] op_sel_hi:[1,0,1]
    v_pk_mul_f32 v[20:21], v[20:21], v[72:73]
    v_pk_fma_f32 v[22:23], v[106:107], v[136:137], v[22:23] op_sel_hi:[1,0,1]
    v_pk_mul_f32 v[22:23], v[22:23], v[74:75]
    v_cvt_pk_bf16_f32 v164, v20, v21
    v_cvt_pk_bf16_f32 v165, v22, v23
    ds_write_b64 v133, v[164:165] offset:32
    v_pk_fma_f32 v[24:25], v[104:105], v[140:141], v[24:25] op_sel_hi:[1,0,1]
    v_pk_mul_f32 v[24:25], v[24:25], v[72:73]
    v_pk_fma_f32 v[26:27], v[106:107], v[140:141], v[26:27] op_sel_hi:[1,0,1]
    v_pk_mul_f32 v[26:27], v[26:27], v[74:75]
    v_cvt_pk_bf16_f32 v164, v24, v25
    v_cvt_pk_bf16_f32 v165, v26, v27
    ds_write_b64 v133, v[164:165] offset:4384
    v_pk_fma_f32 v[28:29], v[104:105], v[144:145], v[28:29] op_sel_hi:[1,0,1]
    v_pk_mul_f32 v[28:29], v[28:29], v[72:73]
    v_pk_fma_f32 v[30:31], v[106:107], v[144:145], v[30:31] op_sel_hi:[1,0,1]
    v_pk_mul_f32 v[30:31], v[30:31], v[74:75]
    v_cvt_pk_bf16_f32 v164, v28, v29
    v_cvt_pk_bf16_f32 v165, v30, v31
    ds_write_b64 v133, v[164:165] offset:8736
    v_pk_fma_f32 v[32:33], v[104:105], v[148:149], v[32:33] op_sel_hi:[1,0,1]
    v_pk_mul_f32 v[32:33], v[32:33], v[72:73]
    v_pk_fma_f32 v[34:35], v[106:107], v[148:149], v[34:35] op_sel_hi:[1,0,1]
    v_pk_mul_f32 v[34:35], v[34:35], v[74:75]
    v_cvt_pk_bf16_f32 v164, v32, v33
    v_cvt_pk_bf16_f32 v165, v34, v35
    ds_write_b64 v133, v[164:165] offset:13088
    v_pk_fma_f32 v[36:37], v[108:109], v[136:137], v[36:37] op_sel_hi:[1,0,1]
    v_pk_mul_f32 v[36:37], v[36:37], v[76:77]
    v_pk_fma_f32 v[38:39], v[110:111], v[136:137], v[38:39] op_sel_hi:[1,0,1]
    v_pk_mul_f32 v[38:39], v[38:39], v[78:79]
    v_cvt_pk_bf16_f32 v164, v36, v37
    v_cvt_pk_bf16_f32 v165, v38, v39
    ds_write_b64 v133, v[164:165] offset:64
    v_pk_fma_f32 v[40:41], v[108:109], v[140:141], v[40:41] op_sel_hi:[1,0,1]
    v_pk_mul_f32 v[40:41], v[40:41], v[76:77]
    v_pk_fma_f32 v[42:43], v[110:111], v[140:141], v[42:43] op_sel_hi:[1,0,1]
    v_pk_mul_f32 v[42:43], v[42:43], v[78:79]
    v_cvt_pk_bf16_f32 v164, v40, v41
    v_cvt_pk_bf16_f32 v165, v42, v43
    ds_write_b64 v133, v[164:165] offset:4416
    v_pk_fma_f32 v[44:45], v[108:109], v[144:145], v[44:45] op_sel_hi:[1,0,1]
    v_pk_mul_f32 v[44:45], v[44:45], v[76:77]
    v_pk_fma_f32 v[46:47], v[110:111], v[144:145], v[46:47] op_sel_hi:[1,0,1]
    v_pk_mul_f32 v[46:47], v[46:47], v[78:79]
    v_cvt_pk_bf16_f32 v164, v44, v45
    v_cvt_pk_bf16_f32 v165, v46, v47
    ds_write_b64 v133, v[164:165] offset:8768
    v_pk_fma_f32 v[48:49], v[108:109], v[148:149], v[48:49] op_sel_hi:[1,0,1]
    v_pk_mul_f32 v[48:49], v[48:49], v[76:77]
    v_pk_fma_f32 v[50:51], v[110:111], v[148:149], v[50:51] op_sel_hi:[1,0,1]
    v_pk_mul_f32 v[50:51], v[50:51], v[78:79]
    v_cvt_pk_bf16_f32 v164, v48, v49
    v_cvt_pk_bf16_f32 v165, v50, v51
    ds_write_b64 v133, v[164:165] offset:13120
    v_pk_fma_f32 v[52:53], v[112:113], v[136:137], v[52:53] op_sel_hi:[1,0,1]
    v_pk_mul_f32 v[52:53], v[52:53], v[80:81]
    v_pk_fma_f32 v[54:55], v[114:115], v[136:137], v[54:55] op_sel_hi:[1,0,1]
    v_pk_mul_f32 v[54:55], v[54:55], v[82:83]
    v_cvt_pk_bf16_f32 v164, v52, v53
    v_cvt_pk_bf16_f32 v165, v54, v55
    ds_write_b64 v133, v[164:165] offset:96
    v_pk_fma_f32 v[56:57], v[112:113], v[140:141], v[56:57] op_sel_hi:[1,0,1]
    v_pk_mul_f32 v[56:57], v[56:57], v[80:81]
    v_pk_fma_f32 v[58:59], v[114:115], v[140:141], v[58:59] op_sel_hi:[1,0,1]
    v_pk_mul_f32 v[58:59], v[58:59], v[82:83]
    v_cvt_pk_bf16_f32 v164, v56, v57
    v_cvt_pk_bf16_f32 v165, v58, v59
    ds_write_b64 v133, v[164:165] offset:4448
    v_pk_fma_f32 v[60:61], v[112:113], v[144:145], v[60:61] op_sel_hi:[1,0,1]
    v_pk_mul_f32 v[60:61], v[60:61], v[80:81]
    v_pk_fma_f32 v[62:63], v[114:115], v[144:145], v[62:63] op_sel_hi:[1,0,1]
    v_pk_mul_f32 v[62:63], v[62:63], v[82:83]
    v_cvt_pk_bf16_f32 v164, v60, v61
    v_cvt_pk_bf16_f32 v165, v62, v63
    ds_write_b64 v133, v[164:165] offset:8800
    v_pk_fma_f32 v[64:65], v[112:113], v[148:149], v[64:65] op_sel_hi:[1,0,1]
    v_pk_mul_f32 v[64:65], v[64:65], v[80:81]
    v_pk_fma_f32 v[66:67], v[114:115], v[148:149], v[66:67] op_sel_hi:[1,0,1]
    v_pk_mul_f32 v[66:67], v[66:67], v[82:83]
    v_cvt_pk_bf16_f32 v164, v64, v65
    v_cvt_pk_bf16_f32 v165, v66, v67
    ds_write_b64 v133, v[164:165] offset:13152
    s_waitcnt lgkmcnt(0)
    s_barrier
    v_and_b32 v133, 15, v0
    v_lshrrev_b32 v134, 4, v0
    v_mul_u32_u24 v135, 272, v134
    v_lshl_add_u32 v135, v133, 4, v135
    s_mov_b32 s63, 11776
    v_mul_lo_u32 v134, v134, s63
    v_lshl_add_u32 v134, v133, 4, v134
    ds_read_b128 v[4:7], v135 offset:0
    ds_read_b128 v[8:11], v135 offset:4352
    ds_read_b128 v[12:15], v135 offset:8704
    ds_read_b128 v[16:19], v135 offset:13056
    ds_read_b128 v[20:23], v135 offset:17408
    ds_read_b128 v[24:27], v135 offset:21760
    ds_read_b128 v[28:31], v135 offset:26112
    ds_read_b128 v[32:35], v135 offset:30464
    s_waitcnt lgkmcnt(7)
    s_add_u32 s63, s9, 0
    buffer_store_dwordx4 v[4:7], v134, s[48:51], s63 offen sc0 sc1
    s_waitcnt lgkmcnt(6)
    s_add_u32 s63, s9, 188416
    buffer_store_dwordx4 v[8:11], v134, s[48:51], s63 offen sc0 sc1
    s_waitcnt lgkmcnt(5)
    s_add_u32 s63, s9, 376832
    buffer_store_dwordx4 v[12:15], v134, s[48:51], s63 offen sc0 sc1
    s_waitcnt lgkmcnt(4)
    s_add_u32 s63, s9, 565248
    buffer_store_dwordx4 v[16:19], v134, s[48:51], s63 offen sc0 sc1
    s_waitcnt lgkmcnt(3)
    s_add_u32 s63, s9, 753664
    buffer_store_dwordx4 v[20:23], v134, s[48:51], s63 offen sc0 sc1
    s_waitcnt lgkmcnt(2)
    s_add_u32 s63, s9, 942080
    buffer_store_dwordx4 v[24:27], v134, s[48:51], s63 offen sc0 sc1
    s_waitcnt lgkmcnt(1)
    s_add_u32 s63, s9, 1130496
    buffer_store_dwordx4 v[28:31], v134, s[48:51], s63 offen sc0 sc1
    s_waitcnt lgkmcnt(0)
    s_add_u32 s63, s9, 1318912
    buffer_store_dwordx4 v[32:35], v134, s[48:51], s63 offen sc0 sc1
    s_waitcnt vmcnt(0)
    s_barrier
    s_branch P2_CMP
P2_LD:
    s_and_b32 s4, s2, 7
    s_lshr_b32 s5, s2, 3
    s_and_b32 s6, s5, 1
    s_lshr_b32 s7, s5, 2
    s_lshl_b32 s7, s7, 1
    s_add_u32 s6, s6, s7
    s_and_b32 s8, s6, 3
    s_lshr_b32 s6, s6, 2
    s_and_b32 s7, s4, 3
    s_lshl_b32 s7, s7, 2
    s_add_u32 s7, s7, s6
    s_lshl_b32 s9, s7, 2
    s_add_u32 s9, s9, s8
    s_lshr_b32 s4, s4, 2
    s_bitcmp1_b32 s5, 1
    s_cselect_b32 s80, 21, 25
    s_cselect_b32 s10, 50, 0
    s_cselect_b32 s6, 2, 0
    s_add_u32 s6, s6, s4
    s_bitcmp1_b32 s5, 1
    s_cselect_b32 s51, 7, 25
    s_cselect_b32 s50, 14, 0
    s_mul_i32 s50, s50, s4
    s_mul_i32 s4, s4, s51
    s_add_u32 s10, s10, s4
    s_add_u32 s51, s50, 64
    s_add_u32 s50, s10, 7
    s_bitcmp1_b32 s5, 1
    s_cselect_b32 s50, s50, 64
    s_add_u32 s40, s36, 0x400000
    s_addc_u32 s41, s37, 0
    s_mov_b32 s42, 0x5c0000
    s_mov_b32 s43, 0x00020000
    s_lshl_b32 s11, s10, 7
    s_and_b32 s12, s10, 31
    s_lshl_b32 s12, s12, 7
    s_add_u32 s14, s36, 0xa00000
    s_addc_u32 s15, s37, 0
    s_cmp_ge_u32 s10, 32
    s_cselect_b32 s44, s20, s18
    s_cselect_b32 s45, s21, s19
    s_cmp_ge_u32 s10, 64
    s_cselect_b32 s44, s14, s44
    s_cselect_b32 s45, s15, s45
    s_mov_b32 s46, 0x800000
    s_mov_b32 s47, 0x00020000
    s_mul_i32 s61, s8, 1507328
    s_lshl_b32 s62, s7, 19
    s_lshl_b32 s48, s51, 7
    s_sub_u32 s49, s51, 64
    s_lshl_b32 s49, s49, 7
    v_and_b32 v2, 63, v0
    v_lshrrev_b32 v3, 3, v2
    v_and_b32 v4, 7, v2
    v_xor_b32 v4, v4, v3
    v_lshlrev_b32 v4, 4, v4
    s_mul_i32 s63, s87, 32
    v_add_u32 v5, s63, v3
    s_mov_b32 s63, 11776
    v_mul_lo_u32 v5, v5, s63
    v_add_u32 v5, v5, v4
    v_add_u32 v5, s61, v5
    v_mov_b32 v8, v5
    v_add_u32 v9, 0x16c00, v5
    v_add_u32 v10, 0x2d800, v5
    v_add_u32 v11, 0x44400, v5
    s_lshl_b32 s63, s87, 5
    v_add_u32 v5, s63, v3
    s_mov_b32 s63, 4096
    v_mul_lo_u32 v5, v5, s63
    v_add_u32 v5, v5, v4
    v_add_u32 v5, s62, v5
    v_mov_b32 v12, v5
    v_add_u32 v13, 0x7c00, v5
    v_add_u32 v14, 0xf800, v5
    v_add_u32 v15, 0x17400, v5
    s_mul_i32 s64, s87, 4096
    s_lshl_b32 s65, s87, 12
    s_add_u32 s65, s65, 16384
    s_mov_b32 s84, 0
    s_add_u32 s52, s36, 0x1e08000
    s_addc_u32 s53, s37, 0
    s_mov_b32 s54, 0x8000
    s_mov_b32 s55, 0x00020000
    s_lshl_b32 s72, s2, 7
    v_mov_b32 v1, s72
    s_bitcmp1_b32 s5, 1
    s_cselect_b32 s56, 3, 65535
    s_cselect_b32 s57, 4, 65535
    s_cselect_b32 s58, 2, 65535
    s_cmp_lg_u32 s60, 4
    s_cbranch_scc1 P2_PH_D
    s_cmp_eq_u32 s6, 0
    s_cselect_b32 s73, 0, 1
    s_cmp_eq_u32 s6, 1
    s_cselect_b32 s73, 0, s73
    s_and_b32 s72, s59, 0xffff
    s_cmpk_eq_u32 s72, 128
    s_cselect_b32 s72, s73, 0
    s_cmp_lg_u32 s72, 0
    s_cbranch_scc1 P2_PH_D
    s_add_u32 s72, s10, 24
    s_lshr_b32 s72, s72, 1
    s_lshr_b32 s73, s10, 1
    s_sub_u32 s72, s72, s73
    s_add_u32 s72, s72, 1
    s_lshl_b32 s72, 1, s72
    s_sub_u32 s72, s72, 1
    s_lshl_b32 s72, s72, 16
    s_cmp_lt_u32 s6, 2
    s_cselect_b32 s72, s72, 0x10000
    v_and_b32 v3, 31, v0
    v_lshl_add_u32 v3, v3, 2, v1
    s_mov_b32 exec_lo, -1
    s_mov_b32 exec_hi, 0
P2_PA:
    buffer_load_dword v2, v3, s[52:55], 0 offen sc0 sc1
    s_waitcnt vmcnt(0)
    v_cmp_ne_u32 vcc, 0, v2
    s_and_b32 s73, vcc_lo, 1
    s_cbranch_scc1 P2_PG
    s_and_b32 s73, vcc_lo, s72
    s_cmp_eq_u32 s73, s72
    s_cbranch_scc1 P2_PG
    s_sleep 4
    s_branch P2_PA
P2_PG:
    s_mov_b64 exec, -1
P2_PH_D:
    s_barrier
    s_add_u32 m0, s84, s64
    s_nop 0
    buffer_load_dwordx4 v8, s[40:43], s11 offen offset:0 lds
    buffer_load_dwordx4 v9, s[40:43], s11 offen offset:1024 lds
    buffer_load_dwordx4 v10, s[40:43], s11 offen offset:2048 lds
    buffer_load_dwordx4 v11, s[40:43], s11 offen offset:3072 lds
    s_add_u32 m0, s84, s65
    s_nop 0
    buffer_load_dwordx4 v12, s[44:47], s12 offen offset:0 lds
    buffer_load_dwordx4 v13, s[44:47], s12 offen offset:1024 lds
    buffer_load_dwordx4 v14, s[44:47], s12 offen offset:2048 lds
    buffer_load_dwordx4 v15, s[44:47], s12 offen offset:3072 lds
    s_add_u32 s11, s11, 128
    s_add_u32 s12, s12, 128
    s_add_u32 s10, s10, 1
    s_cmp_eq_u32 s10, 32
    s_cselect_b32 s44, s20, s44
    s_cselect_b32 s45, s21, s45
    s_cselect_b32 s12, 0, s12
    s_cmp_eq_u32 s10, s50
    s_cselect_b32 s44, s14, s44
    s_cselect_b32 s45, s15, s45
    s_cselect_b32 s12, s49, s12
    s_cselect_b32 s11, s48, s11
    s_cselect_b32 s10, s51, s10
    s_add_u32 s84, s84, 32768
    s_cmp_eq_u32 s84, 131072
    s_cselect_b32 s84, 0, s84
    s_add_u32 m0, s84, s64
    s_nop 0
    buffer_load_dwordx4 v8, s[40:43], s11 offen offset:0 lds
    buffer_load_dwordx4 v9, s[40:43], s11 offen offset:1024 lds
    buffer_load_dwordx4 v10, s[40:43], s11 offen offset:2048 lds
    buffer_load_dwordx4 v11, s[40:43], s11 offen offset:3072 lds
    s_add_u32 m0, s84, s65
    s_nop 0
    buffer_load_dwordx4 v12, s[44:47], s12 offen offset:0 lds
    buffer_load_dwordx4 v13, s[44:47], s12 offen offset:1024 lds
    buffer_load_dwordx4 v14, s[44:47], s12 offen offset:2048 lds
    buffer_load_dwordx4 v15, s[44:47], s12 offen offset:3072 lds
    s_add_u32 s11, s11, 128
    s_add_u32 s12, s12, 128
    s_add_u32 s10, s10, 1
    s_cmp_eq_u32 s10, 32
    s_cselect_b32 s44, s20, s44
    s_cselect_b32 s45, s21, s45
    s_cselect_b32 s12, 0, s12
    s_cmp_eq_u32 s10, s50
    s_cselect_b32 s44, s14, s44
    s_cselect_b32 s45, s15, s45
    s_cselect_b32 s12, s49, s12
    s_cselect_b32 s11, s48, s11
    s_cselect_b32 s10, s51, s10
    s_add_u32 s84, s84, 32768
    s_cmp_eq_u32 s84, 131072
    s_cselect_b32 s84, 0, s84
    s_add_u32 m0, s84, s64
    s_nop 0
    buffer_load_dwordx4 v8, s[40:43], s11 offen offset:0 lds
    buffer_load_dwordx4 v9, s[40:43], s11 offen offset:1024 lds
    buffer_load_dwordx4 v10, s[40:43], s11 offen offset:2048 lds
    buffer_load_dwordx4 v11, s[40:43], s11 offen offset:3072 lds
    s_add_u32 m0, s84, s65
    s_nop 0
    buffer_load_dwordx4 v12, s[44:47], s12 offen offset:0 lds
    buffer_load_dwordx4 v13, s[44:47], s12 offen offset:1024 lds
    buffer_load_dwordx4 v14, s[44:47], s12 offen offset:2048 lds
    buffer_load_dwordx4 v15, s[44:47], s12 offen offset:3072 lds
    s_add_u32 s11, s11, 128
    s_add_u32 s12, s12, 128
    s_add_u32 s10, s10, 1
    s_cmp_eq_u32 s10, 32
    s_cselect_b32 s44, s20, s44
    s_cselect_b32 s45, s21, s45
    s_cselect_b32 s12, 0, s12
    s_cmp_eq_u32 s10, s50
    s_cselect_b32 s44, s14, s44
    s_cselect_b32 s45, s15, s45
    s_cselect_b32 s12, s49, s12
    s_cselect_b32 s11, s48, s11
    s_cselect_b32 s10, s51, s10
    s_add_u32 s84, s84, 32768
    s_cmp_eq_u32 s84, 131072
    s_cselect_b32 s84, 0, s84
    s_waitcnt vmcnt(16)
    s_barrier
    s_sub_u32 s81, s80, 3
    s_mov_b32 s85, 0
LLOOP_k2:
    s_cmp_eq_u32 s85, s56
    s_cbranch_scc1 KX_W9
    s_waitcnt vmcnt(8)
KX_WB:
    s_barrier
    s_cmp_eq_u32 s85, s57
    s_cbranch_scc1 KX_CHK
KX_CHKD:
    s_add_u32 m0, s84, s64
    s_nop 0
    buffer_load_dwordx4 v8, s[40:43], s11 offen offset:0 lds
    buffer_load_dwordx4 v9, s[40:43], s11 offen offset:1024 lds
    buffer_load_dwordx4 v10, s[40:43], s11 offen offset:2048 lds
    buffer_load_dwordx4 v11, s[40:43], s11 offen offset:3072 lds
    s_add_u32 m0, s84, s65
    s_nop 0
    buffer_load_dwordx4 v12, s[44:47], s12 offen offset:0 lds
    buffer_load_dwordx4 v13, s[44:47], s12 offen offset:1024 lds
    buffer_load_dwordx4 v14, s[44:47], s12 offen offset:2048 lds
    buffer_load_dwordx4 v15, s[44:47], s12 offen offset:3072 lds
    s_add_u32 s11, s11, 128
    s_add_u32 s12, s12, 128
    s_add_u32 s10, s10, 1
    s_cmp_eq_u32 s10, 32
    s_cselect_b32 s44, s20, s44
    s_cselect_b32 s45, s21, s45
    s_cselect_b32 s12, 0, s12
    s_cmp_eq_u32 s10, s50
    s_cselect_b32 s44, s14, s44
    s_cselect_b32 s45, s15, s45
    s_cselect_b32 s12, s49, s12
    s_cselect_b32 s11, s48, s11
    s_cselect_b32 s10, s51, s10
    s_add_u32 s84, s84, 32768
    s_cmp_eq_u32 s84, 131072
    s_cselect_b32 s84, 0, s84
    s_cmp_eq_u32 s85, s58
    s_cbranch_scc1 KX_POLL
KX_POLLD:
    s_add_u32 s85, s85, 1
    s_cmp_lt_u32 s85, s81
    s_cbranch_scc1 LLOOP_k2
    s_waitcnt vmcnt(8)
    s_barrier
    s_waitcnt vmcnt(0)
    s_barrier
    s_waitcnt vmcnt(0)
    s_barrier
    s_endpgm
KX_W9:
    s_waitcnt vmcnt(9)
    s_branch KX_WB
KX_POLL:
    buffer_load_dword v6, v1, s[52:55], 0 offen sc0 sc1
    s_branch KX_POLLD
KX_SPIN:
    s_sleep 4
    buffer_load_dword v6, v1, s[52:55], 0 offen sc0 sc1
    s_waitcnt vmcnt(0)
KX_CHK:
    v_readfirstlane_b32 s73, v6
    s_cmp_lg_u32 s73, 0
    s_cbranch_scc1 KX_CHKD
    s_branch KX_SPIN
P2_CMP:
    s_and_b32 s4, s2, 7
    s_lshr_b32 s5, s2, 3
    s_and_b32 s6, s5, 1
    s_lshr_b32 s7, s5, 2
    s_lshl_b32 s7, s7, 1
    s_add_u32 s6, s6, s7
    s_and_b32 s8, s6, 3
    s_lshr_b32 s6, s6, 2
    s_and_b32 s7, s4, 3
    s_lshl_b32 s7, s7, 2
    s_add_u32 s7, s7, s6
    s_lshl_b32 s9, s7, 2
    s_add_u32 s9, s9, s8
    s_lshr_b32 s4, s4, 2
    s_bitcmp1_b32 s5, 1
    s_cselect_b32 s80, 21, 25
    s_cselect_b32 s10, 50, 0
    s_cselect_b32 s6, 2, 0
    s_add_u32 s6, s6, s4
    s_bitcmp1_b32 s5, 1
    s_cselect_b32 s51, 7, 25
    s_cselect_b32 s50, 14, 0
    s_mul_i32 s50, s50, s4
    s_mul_i32 s4, s4, s51
    s_add_u32 s10, s10, s4
    s_add_u32 s51, s50, 64
    s_add_u32 s50, s10, 7
    s_bitcmp1_b32 s5, 1
    s_cselect_b32 s50, s50, 64
    s_mov_b32 s48, s32
    s_mov_b32 s49, s33
    s_mov_b32 s50, 0x200000
    s_mov_b32 s51, 0x00020000
    s_mov_b32 s52, s16
    s_mov_b32 s53, s17
    s_mov_b32 s54, 0x200000
    s_mov_b32 s55, 0x00020000
    s_add_u32 s56, s36, 0x3000000
    s_addc_u32 s57, s37, 0
    s_mov_b32 s58, 0x1000000
    s_mov_b32 s59, 0x00020000
    s_add_u32 s76, s36, 0x1e00000
    s_addc_u32 s77, s37, 0
    s_mov_b32 s78, 0x8000
    s_mov_b32 s79, 0x00020000
    v_and_b32 v2, 63, v0
    v_lshrrev_b32 v3, 3, v2
    v_and_b32 v2, 3, v2
    v_lshlrev_b32 v2, 7, v2
    v_lshl_add_u32 v2, v3, 12, v2
    s_lshl_b32 s70, s7, 7
    s_lshl_b32 s71, s8, 5
    s_add_u32 s70, s70, s71
    s_lshl_b32 s71, s87, 3
    s_add_u32 s70, s70, s71
    s_lshl_b32 s70, s70, 12
    s_mov_b32 s71, s10
    s_add_u32 s72, s71, 4
    s_and_b32 s71, s71, 0xfffffffc
    s_mov_b32 s42, 0x800000
    s_mov_b32 s43, 0x00020000
K2PF_L:
    s_cmp_gt_u32 s71, s72
    s_cbranch_scc1 K2PF_E
    s_cmp_ge_u32 s71, 64
    s_cbranch_scc1 K2PF_E
    s_cmp_lt_u32 s71, 32
    s_cselect_b32 s40, s18, s20
    s_cselect_b32 s41, s19, s21
    s_and_b32 s73, s71, 31
    s_lshl_b32 s73, s73, 7
    s_add_u32 s73, s73, s70
    buffer_load_dword v3, v2, s[40:43], s73 offen
    s_add_u32 s71, s71, 4
    s_branch K2PF_L
K2PF_E:
    v_and_b32 v132, 63, v0
    v_and_b32 v133, 15, v132
    v_lshrrev_b32 v134, 4, v132
    v_and_b32 v135, 7, v132
    v_xor_b32 v134, v134, v135
    v_lshlrev_b32 v134, 4, v134
    v_lshl_add_u32 v134, v133, 7, v134
    s_lshr_b32 s66, s87, 1
    s_and_b32 s67, s87, 1
    s_mul_i32 s68, s66, 8192
    s_lshl_b32 s69, s67, 13
    s_add_u32 s69, s69, 16384
    v_add_u32 v136, s68, v134
    v_add_u32 v138, s69, v134
    v_add_u32 v140, s68, v134
    v_xor_b32 v140, 64, v140
    v_add_u32 v142, s69, v134
    v_xor_b32 v142, 64, v142
    v_mov_b32 v4, 0
    v_mov_b32 v5, 0
    v_mov_b32 v6, 0
    v_mov_b32 v7, 0
    v_mov_b32 v8, 0
    v_mov_b32 v9, 0
    v_mov_b32 v10, 0
    v_mov_b32 v11, 0
    v_mov_b32 v12, 0
    v_mov_b32 v13, 0
    v_mov_b32 v14, 0
    v_mov_b32 v15, 0
    v_mov_b32 v16, 0
    v_mov_b32 v17, 0
    v_mov_b32 v18, 0
    v_mov_b32 v19, 0
    v_mov_b32 v20, 0
    v_mov_b32 v21, 0
    v_mov_b32 v22, 0
    v_mov_b32 v23, 0
    v_mov_b32 v24, 0
    v_mov_b32 v25, 0
    v_mov_b32 v26, 0
    v_mov_b32 v27, 0
    v_mov_b32 v28, 0
    v_mov_b32 v29, 0
    v_mov_b32 v30, 0
    v_mov_b32 v31, 0
    v_mov_b32 v32, 0
    v_mov_b32 v33, 0
    v_mov_b32 v34, 0
    v_mov_b32 v35, 0
    v_mov_b32 v36, 0
    v_mov_b32 v37, 0
    v_mov_b32 v38, 0
    v_mov_b32 v39, 0
    v_mov_b32 v40, 0
    v_mov_b32 v41, 0
    v_mov_b32 v42, 0
    v_mov_b32 v43, 0
    v_mov_b32 v44, 0
    v_mov_b32 v45, 0
    v_mov_b32 v46, 0
    v_mov_b32 v47, 0
    v_mov_b32 v48, 0
    v_mov_b32 v49, 0
    v_mov_b32 v50, 0
    v_mov_b32 v51, 0
    v_mov_b32 v52, 0
    v_mov_b32 v53, 0
    v_mov_b32 v54, 0
    v_mov_b32 v55, 0
    v_mov_b32 v56, 0
    v_mov_b32 v57, 0
    v_mov_b32 v58, 0
    v_mov_b32 v59, 0
    v_mov_b32 v60, 0
    v_mov_b32 v61, 0
    v_mov_b32 v62, 0
    v_mov_b32 v63, 0
    v_mov_b32 v64, 0
    v_mov_b32 v65, 0
    v_mov_b32 v66, 0
    v_mov_b32 v67, 0
    s_mov_b32 s82, 0
    s_mov_b32 s83, 32768
    s_mov_b32 s85, 0
    s_barrier
    s_barrier
    v_add_u32 v137, s82, v136
    v_add_u32 v139, s82, v138
    ds_read_b128 v[68:71], v137 offset:0
    ds_read_b128 v[84:87], v139 offset:0
    ds_read_b128 v[88:91], v139 offset:2048
    ds_read_b128 v[92:95], v139 offset:4096
    ds_read_b128 v[96:99], v139 offset:6144
    ds_read_b128 v[72:75], v137 offset:2048
    ds_read_b128 v[76:79], v137 offset:4096
    ds_read_b128 v[80:83], v137 offset:6144
    v_add_u32 v141, s82, v140
    v_add_u32 v143, s82, v142
LOOP_k2:
    s_waitcnt lgkmcnt(3)
    v_mfma_f32_16x16x32_bf16 v[4:7], v[68:71], v[84:87], v[4:7]
    ds_read_b128 v[100:103], v141 offset:0
    v_mfma_f32_16x16x32_bf16 v[8:11], v[68:71], v[88:91], v[8:11]
    ds_read_b128 v[116:119], v143 offset:0
    v_mfma_f32_16x16x32_bf16 v[12:15], v[68:71], v[92:95], v[12:15]
    ds_read_b128 v[120:123], v143 offset:2048
    v_mfma_f32_16x16x32_bf16 v[16:19], v[68:71], v[96:99], v[16:19]
    ds_read_b128 v[124:127], v143 offset:4096
    s_waitcnt lgkmcnt(6)
    v_mfma_f32_16x16x32_bf16 v[20:23], v[72:75], v[84:87], v[20:23]
    ds_read_b128 v[128:131], v143 offset:6144
    v_mfma_f32_16x16x32_bf16 v[24:27], v[72:75], v[88:91], v[24:27]
    ds_read_b128 v[104:107], v141 offset:2048
    v_mfma_f32_16x16x32_bf16 v[28:31], v[72:75], v[92:95], v[28:31]
    ds_read_b128 v[108:111], v141 offset:4096
    v_mfma_f32_16x16x32_bf16 v[32:35], v[72:75], v[96:99], v[32:35]
    ds_read_b128 v[112:115], v141 offset:6144
    s_waitcnt lgkmcnt(9)
    v_mfma_f32_16x16x32_bf16 v[36:39], v[76:79], v[84:87], v[36:39]
    v_add_u32 v137, s83, v136
    v_mfma_f32_16x16x32_bf16 v[40:43], v[76:79], v[88:91], v[40:43]
    v_add_u32 v139, s83, v138
    v_mfma_f32_16x16x32_bf16 v[44:47], v[76:79], v[92:95], v[44:47]
    s_add_u32 s72, s72, 1
    s_and_b32 s71, s72, 3
    s_cmp_lg_u32 s71, 0
    s_cbranch_scc1 K2PF_N
    s_cmp_ge_u32 s72, 64
    s_cbranch_scc1 K2PF_N
    s_mov_b32 s71, s72
    s_cmp_lt_u32 s71, 32
    s_cselect_b32 s40, s18, s20
    s_cselect_b32 s41, s19, s21
    s_and_b32 s73, s71, 31
    s_lshl_b32 s73, s73, 7
    s_add_u32 s73, s73, s70
    buffer_load_dword v3, v2, s[40:43], s73 offen
K2PF_N:
    v_mfma_f32_16x16x32_bf16 v[48:51], v[76:79], v[96:99], v[48:51]
    s_waitcnt lgkmcnt(8)
    v_mfma_f32_16x16x32_bf16 v[52:55], v[80:83], v[84:87], v[52:55]
    v_mfma_f32_16x16x32_bf16 v[56:59], v[80:83], v[88:91], v[56:59]
    v_mfma_f32_16x16x32_bf16 v[60:63], v[80:83], v[92:95], v[60:63]
    v_mfma_f32_16x16x32_bf16 v[64:67], v[80:83], v[96:99], v[64:67]
    s_barrier
    s_waitcnt lgkmcnt(3)
    v_mfma_f32_16x16x32_bf16 v[4:7], v[100:103], v[116:119], v[4:7]
    ds_read_b128 v[68:71], v137 offset:0
    v_mfma_f32_16x16x32_bf16 v[8:11], v[100:103], v[120:123], v[8:11]
    ds_read_b128 v[84:87], v139 offset:0
    v_mfma_f32_16x16x32_bf16 v[12:15], v[100:103], v[124:127], v[12:15]
    ds_read_b128 v[88:91], v139 offset:2048
    v_mfma_f32_16x16x32_bf16 v[16:19], v[100:103], v[128:131], v[16:19]
    ds_read_b128 v[92:95], v139 offset:4096
    s_waitcnt lgkmcnt(6)
    v_mfma_f32_16x16x32_bf16 v[20:23], v[104:107], v[116:119], v[20:23]
    ds_read_b128 v[96:99], v139 offset:6144
    v_mfma_f32_16x16x32_bf16 v[24:27], v[104:107], v[120:123], v[24:27]
    ds_read_b128 v[72:75], v137 offset:2048
    v_mfma_f32_16x16x32_bf16 v[28:31], v[104:107], v[124:127], v[28:31]
    ds_read_b128 v[76:79], v137 offset:4096
    v_mfma_f32_16x16x32_bf16 v[32:35], v[104:107], v[128:131], v[32:35]
    ds_read_b128 v[80:83], v137 offset:6144
    s_waitcnt lgkmcnt(9)
    v_mfma_f32_16x16x32_bf16 v[36:39], v[108:111], v[116:119], v[36:39]
    v_add_u32 v141, s83, v140
    v_mfma_f32_16x16x32_bf16 v[40:43], v[108:111], v[120:123], v[40:43]
    v_add_u32 v143, s83, v142
    v_mfma_f32_16x16x32_bf16 v[44:47], v[108:111], v[124:127], v[44:47]
    s_mov_b32 s82, s83
    v_mfma_f32_16x16x32_bf16 v[48:51], v[108:111], v[128:131], v[48:51]
    s_add_u32 s83, s83, 32768
    s_waitcnt lgkmcnt(8)
    v_mfma_f32_16x16x32_bf16 v[52:55], v[112:115], v[116:119], v[52:55]
    s_cmp_eq_u32 s83, 131072
    v_mfma_f32_16x16x32_bf16 v[56:59], v[112:115], v[120:123], v[56:59]
    s_cselect_b32 s83, 0, s83
    v_mfma_f32_16x16x32_bf16 v[60:63], v[112:115], v[124:127], v[60:63]
    s_add_u32 s85, s85, 1
    v_mfma_f32_16x16x32_bf16 v[64:67], v[112:115], v[128:131], v[64:67]
    s_cmp_lt_u32 s85, s80
    s_cbranch_scc1 LOOP_k2
    s_waitcnt lgkmcnt(0)
    s_nop 7
    s_nop 7
    v_and_b32 v132, 63, v0
    v_and_b32 v133, 15, v132
    v_lshrrev_b32 v134, 4, v132
    s_lshl_b32 s70, s7, 7
    s_lshl_b32 s71, s67, 6
    s_add_u32 s70, s70, s71
    s_lshl_b32 s71, s6, 4
    s_add_u32 s70, s70, s71
    v_add_u32 v133, s70, v133
    v_lshlrev_b32 v133, 10, v133
    v_lshl_add_u32 v133, v134, 3, v133
    s_lshl_b32 s70, s8, 8
    s_lshl_b32 s71, s66, 7
    s_add_u32 s70, s70, s71
    v_add_u32 v152, s70, v133
    buffer_load_dwordx2 v[144:145], v152, s[52:55], 0 offen offset:0
    buffer_load_dwordx2 v[146:147], v152, s[52:55], 0 offen offset:32
    buffer_load_dwordx2 v[148:149], v152, s[52:55], 0 offen offset:64
    buffer_load_dwordx2 v[150:151], v152, s[52:55], 0 offen offset:96
    v_lshlrev_b32 v132, 4, v132
    s_lshl_b32 s75, s87, 12
    v_add_u32 v132, s75, v132
    s_lshl_b32 s74, s9, 18
    s_lshl_b32 s13, s9, 2
    s_add_u32 s13, s13, s87
    s_lshl_b32 s13, s13, 7
    s_cmp_lg_u32 s6, 0
    s_cbranch_scc1 K2_T1
    s_add_u32 s75, s74, 65536
    v_cvt_pk_bf16_f32 v8, v8, v9
    v_cvt_pk_bf16_f32 v9, v10, v11
    v_cvt_pk_bf16_f32 v10, v24, v25
    v_cvt_pk_bf16_f32 v11, v26, v27
    buffer_store_dwordx4 v[8:11], v132, s[56:59], s75 offen offset:0 sc0 sc1
    v_cvt_pk_bf16_f32 v40, v40, v41
    v_cvt_pk_bf16_f32 v41, v42, v43
    v_cvt_pk_bf16_f32 v42, v56, v57
    v_cvt_pk_bf16_f32 v43, v58, v59
    buffer_store_dwordx4 v[40:43], v132, s[56:59], s75 offen offset:1024 sc0 sc1
    s_add_u32 s75, s74, 131072
    v_cvt_pk_bf16_f32 v12, v12, v13
    v_cvt_pk_bf16_f32 v13, v14, v15
    v_cvt_pk_bf16_f32 v14, v28, v29
    v_cvt_pk_bf16_f32 v15, v30, v31
    buffer_store_dwordx4 v[12:15], v132, s[56:59], s75 offen offset:0 sc0 sc1
    v_cvt_pk_bf16_f32 v44, v44, v45
    v_cvt_pk_bf16_f32 v45, v46, v47
    v_cvt_pk_bf16_f32 v46, v60, v61
    v_cvt_pk_bf16_f32 v47, v62, v63
    buffer_store_dwordx4 v[44:47], v132, s[56:59], s75 offen offset:1024 sc0 sc1
    s_add_u32 s75, s74, 196608
    v_cvt_pk_bf16_f32 v16, v16, v17
    v_cvt_pk_bf16_f32 v17, v18, v19
    v_cvt_pk_bf16_f32 v18, v32, v33
    v_cvt_pk_bf16_f32 v19, v34, v35
    buffer_store_dwordx4 v[16:19], v132, s[56:59], s75 offen offset:0 sc0 sc1
    v_cvt_pk_bf16_f32 v48, v48, v49
    v_cvt_pk_bf16_f32 v49, v50, v51
    v_cvt_pk_bf16_f32 v50, v64, v65
    v_cvt_pk_bf16_f32 v51, v66, v67
    buffer_store_dwordx4 v[48:51], v132, s[56:59], s75 offen offset:1024 sc0 sc1
    s_waitcnt vmcnt(0)
    s_mov_b64 exec, 1
    v_mov_b32 v133, s13
    v_mov_b32 v134, 1
    buffer_atomic_add v134, v133, s[76:79], 0 offen sc1
    buffer_load_dword v135, v133, s[76:79], 0 offen sc0 sc1
    s_mov_b64 exec, -1
    s_mov_b32 s84, 0x3f80
    s_mov_b32 s86, 0x3f800000
    v_dot2_f32_bf16 v4, v144, s84, v4
    v_dot2_f32_bf16 v5, v144, s86, v5
    v_dot2_f32_bf16 v6, v145, s84, v6
    v_dot2_f32_bf16 v7, v145, s86, v7
    v_dot2_f32_bf16 v20, v146, s84, v20
    v_dot2_f32_bf16 v21, v146, s86, v21
    v_dot2_f32_bf16 v22, v147, s84, v22
    v_dot2_f32_bf16 v23, v147, s86, v23
    v_dot2_f32_bf16 v36, v148, s84, v36
    v_dot2_f32_bf16 v37, v148, s86, v37
    v_dot2_f32_bf16 v38, v149, s84, v38
    v_dot2_f32_bf16 v39, v149, s86, v39
    v_dot2_f32_bf16 v52, v150, s84, v52
    v_dot2_f32_bf16 v53, v150, s86, v53
    v_dot2_f32_bf16 v54, v151, s84, v54
    v_dot2_f32_bf16 v55, v151, s86, v55
    s_mov_b64 exec, 1
    s_waitcnt vmcnt(0)
    v_readfirstlane_b32 s73, v135
    s_cmp_ge_u32 s73, 4
    s_cbranch_scc1 K2_PD0
K2_POLL0:
    buffer_load_dword v134, v133, s[76:79], 0 offen sc0 sc1
    s_waitcnt vmcnt(0)
    v_readfirstlane_b32 s73, v134
    s_cmp_ge_u32 s73, 4
    s_cbranch_scc1 K2_PD0
    s_sleep 1
    s_branch K2_POLL0
K2_PD0:
    s_mov_b64 exec, -1
    s_add_u32 s75, s74, 16384
    buffer_load_dwordx4 v[68:71], v132, s[56:59], s75 offen offset:0 sc0 sc1
    buffer_load_dwordx4 v[72:75], v132, s[56:59], s75 offen offset:1024 sc0 sc1
    s_add_u32 s75, s74, 32768
    buffer_load_dwordx4 v[76:79], v132, s[56:59], s75 offen offset:0 sc0 sc1
    buffer_load_dwordx4 v[80:83], v132, s[56:59], s75 offen offset:1024 sc0 sc1
    s_add_u32 s75, s74, 49152
    buffer_load_dwordx4 v[84:87], v132, s[56:59], s75 offen offset:0 sc0 sc1
    buffer_load_dwordx4 v[88:91], v132, s[56:59], s75 offen offset:1024 sc0 sc1
    s_waitcnt vmcnt(5)
    v_dot2_f32_bf16 v4, v68, s84, v4
    v_dot2_f32_bf16 v5, v68, s86, v5
    v_dot2_f32_bf16 v6, v69, s84, v6
    v_dot2_f32_bf16 v7, v69, s86, v7
    v_dot2_f32_bf16 v20, v70, s84, v20
    v_dot2_f32_bf16 v21, v70, s86, v21
    v_dot2_f32_bf16 v22, v71, s84, v22
    v_dot2_f32_bf16 v23, v71, s86, v23
    s_waitcnt vmcnt(4)
    v_dot2_f32_bf16 v36, v72, s84, v36
    v_dot2_f32_bf16 v37, v72, s86, v37
    v_dot2_f32_bf16 v38, v73, s84, v38
    v_dot2_f32_bf16 v39, v73, s86, v39
    v_dot2_f32_bf16 v52, v74, s84, v52
    v_dot2_f32_bf16 v53, v74, s86, v53
    v_dot2_f32_bf16 v54, v75, s84, v54
    v_dot2_f32_bf16 v55, v75, s86, v55
    s_waitcnt vmcnt(3)
    v_dot2_f32_bf16 v4, v76, s84, v4
    v_dot2_f32_bf16 v5, v76, s86, v5
    v_dot2_f32_bf16 v6, v77, s84, v6
    v_dot2_f32_bf16 v7, v77, s86, v7
    v_dot2_f32_bf16 v20, v78, s84, v20
    v_dot2_f32_bf16 v21, v78, s86, v21
    v_dot2_f32_bf16 v22, v79, s84, v22
    v_dot2_f32_bf16 v23, v79, s86, v23
    s_waitcnt vmcnt(2)
    v_dot2_f32_bf16 v36, v80, s84, v36
    v_dot2_f32_bf16 v37, v80, s86, v37
    v_dot2_f32_bf16 v38, v81, s84, v38
    v_dot2_f32_bf16 v39, v81, s86, v39
    v_dot2_f32_bf16 v52, v82, s84, v52
    v_dot2_f32_bf16 v53, v82, s86, v53
    v_dot2_f32_bf16 v54, v83, s84, v54
    v_dot2_f32_bf16 v55, v83, s86, v55
    s_waitcnt vmcnt(1)
    v_dot2_f32_bf16 v4, v84, s84, v4
    v_dot2_f32_bf16 v5, v84, s86, v5
    v_dot2_f32_bf16 v6, v85, s84, v6
    v_dot2_f32_bf16 v7, v85, s86, v7
    v_dot2_f32_bf16 v20, v86, s84, v20
    v_dot2_f32_bf16 v21, v86, s86, v21
    v_dot2_f32_bf16 v22, v87, s84, v22
    v_dot2_f32_bf16 v23, v87, s86, v23
    s_waitcnt vmcnt(0)
    v_dot2_f32_bf16 v36, v88, s84, v36
    v_dot2_f32_bf16 v37, v88, s86, v37
    v_dot2_f32_bf16 v38, v89, s84, v38
    v_dot2_f32_bf16 v39, v89, s86, v39
    v_dot2_f32_bf16 v52, v90, s84, v52
    v_dot2_f32_bf16 v53, v90, s86, v53
    v_dot2_f32_bf16 v54, v91, s84, v54
    v_dot2_f32_bf16 v55, v91, s86, v55
    s_nop 1
    v_cvt_pk_bf16_f32 v144, v4, v5
    v_cvt_pk_bf16_f32 v145, v6, v7
    buffer_store_dwordx2 v[144:145], v152, s[48:51], 0 offen offset:0
    v_cvt_pk_bf16_f32 v146, v20, v21
    v_cvt_pk_bf16_f32 v147, v22, v23
    buffer_store_dwordx2 v[146:147], v152, s[48:51], 0 offen offset:32
    v_cvt_pk_bf16_f32 v148, v36, v37
    v_cvt_pk_bf16_f32 v149, v38, v39
    buffer_store_dwordx2 v[148:149], v152, s[48:51], 0 offen offset:64
    v_cvt_pk_bf16_f32 v150, v52, v53
    v_cvt_pk_bf16_f32 v151, v54, v55
    buffer_store_dwordx2 v[150:151], v152, s[48:51], 0 offen offset:96
    s_endpgm
K2_T1:
    s_cmp_lg_u32 s6, 1
    s_cbranch_scc1 K2_T2
    s_add_u32 s75, s74, 16384
    v_cvt_pk_bf16_f32 v4, v4, v5
    v_cvt_pk_bf16_f32 v5, v6, v7
    v_cvt_pk_bf16_f32 v6, v20, v21
    v_cvt_pk_bf16_f32 v7, v22, v23
    buffer_store_dwordx4 v[4:7], v132, s[56:59], s75 offen offset:0 sc0 sc1
    v_cvt_pk_bf16_f32 v36, v36, v37
    v_cvt_pk_bf16_f32 v37, v38, v39
    v_cvt_pk_bf16_f32 v38, v52, v53
    v_cvt_pk_bf16_f32 v39, v54, v55
    buffer_store_dwordx4 v[36:39], v132, s[56:59], s75 offen offset:1024 sc0 sc1
    s_add_u32 s75, s74, 147456
    v_cvt_pk_bf16_f32 v12, v12, v13
    v_cvt_pk_bf16_f32 v13, v14, v15
    v_cvt_pk_bf16_f32 v14, v28, v29
    v_cvt_pk_bf16_f32 v15, v30, v31
    buffer_store_dwordx4 v[12:15], v132, s[56:59], s75 offen offset:0 sc0 sc1
    v_cvt_pk_bf16_f32 v44, v44, v45
    v_cvt_pk_bf16_f32 v45, v46, v47
    v_cvt_pk_bf16_f32 v46, v60, v61
    v_cvt_pk_bf16_f32 v47, v62, v63
    buffer_store_dwordx4 v[44:47], v132, s[56:59], s75 offen offset:1024 sc0 sc1
    s_add_u32 s75, s74, 212992
    v_cvt_pk_bf16_f32 v16, v16, v17
    v_cvt_pk_bf16_f32 v17, v18, v19
    v_cvt_pk_bf16_f32 v18, v32, v33
    v_cvt_pk_bf16_f32 v19, v34, v35
    buffer_store_dwordx4 v[16:19], v132, s[56:59], s75 offen offset:0 sc0 sc1
    v_cvt_pk_bf16_f32 v48, v48, v49
    v_cvt_pk_bf16_f32 v49, v50, v51
    v_cvt_pk_bf16_f32 v50, v64, v65
    v_cvt_pk_bf16_f32 v51, v66, v67
    buffer_store_dwordx4 v[48:51], v132, s[56:59], s75 offen offset:1024 sc0 sc1
    s_waitcnt vmcnt(0)
    s_mov_b64 exec, 1
    v_mov_b32 v133, s13
    v_mov_b32 v134, 1
    buffer_atomic_add v134, v133, s[76:79], 0 offen sc1
    buffer_load_dword v135, v133, s[76:79], 0 offen sc0 sc1
    s_mov_b64 exec, -1
    s_mov_b32 s84, 0x3f80
    s_mov_b32 s86, 0x3f800000
    v_dot2_f32_bf16 v8, v144, s84, v8
    v_dot2_f32_bf16 v9, v144, s86, v9
    v_dot2_f32_bf16 v10, v145, s84, v10
    v_dot2_f32_bf16 v11, v145, s86, v11
    v_dot2_f32_bf16 v24, v146, s84, v24
    v_dot2_f32_bf16 v25, v146, s86, v25
    v_dot2_f32_bf16 v26, v147, s84, v26
    v_dot2_f32_bf16 v27, v147, s86, v27
    v_dot2_f32_bf16 v40, v148, s84, v40
    v_dot2_f32_bf16 v41, v148, s86, v41
    v_dot2_f32_bf16 v42, v149, s84, v42
    v_dot2_f32_bf16 v43, v149, s86, v43
    v_dot2_f32_bf16 v56, v150, s84, v56
    v_dot2_f32_bf16 v57, v150, s86, v57
    v_dot2_f32_bf16 v58, v151, s84, v58
    v_dot2_f32_bf16 v59, v151, s86, v59
    s_mov_b64 exec, 1
    s_waitcnt vmcnt(0)
    v_readfirstlane_b32 s73, v135
    s_cmp_ge_u32 s73, 4
    s_cbranch_scc1 K2_PD1
K2_POLL1:
    buffer_load_dword v134, v133, s[76:79], 0 offen sc0 sc1
    s_waitcnt vmcnt(0)
    v_readfirstlane_b32 s73, v134
    s_cmp_ge_u32 s73, 4
    s_cbranch_scc1 K2_PD1
    s_sleep 1
    s_branch K2_POLL1
K2_PD1:
    s_mov_b64 exec, -1
    s_add_u32 s75, s74, 65536
    buffer_load_dwordx4 v[68:71], v132, s[56:59], s75 offen offset:0 sc0 sc1
    buffer_load_dwordx4 v[72:75], v132, s[56:59], s75 offen offset:1024 sc0 sc1
    s_add_u32 s75, s74, 98304
    buffer_load_dwordx4 v[76:79], v132, s[56:59], s75 offen offset:0 sc0 sc1
    buffer_load_dwordx4 v[80:83], v132, s[56:59], s75 offen offset:1024 sc0 sc1
    s_add_u32 s75, s74, 114688
    buffer_load_dwordx4 v[84:87], v132, s[56:59], s75 offen offset:0 sc0 sc1
    buffer_load_dwordx4 v[88:91], v132, s[56:59], s75 offen offset:1024 sc0 sc1
    s_waitcnt vmcnt(5)
    v_dot2_f32_bf16 v8, v68, s84, v8
    v_dot2_f32_bf16 v9, v68, s86, v9
    v_dot2_f32_bf16 v10, v69, s84, v10
    v_dot2_f32_bf16 v11, v69, s86, v11
    v_dot2_f32_bf16 v24, v70, s84, v24
    v_dot2_f32_bf16 v25, v70, s86, v25
    v_dot2_f32_bf16 v26, v71, s84, v26
    v_dot2_f32_bf16 v27, v71, s86, v27
    s_waitcnt vmcnt(4)
    v_dot2_f32_bf16 v40, v72, s84, v40
    v_dot2_f32_bf16 v41, v72, s86, v41
    v_dot2_f32_bf16 v42, v73, s84, v42
    v_dot2_f32_bf16 v43, v73, s86, v43
    v_dot2_f32_bf16 v56, v74, s84, v56
    v_dot2_f32_bf16 v57, v74, s86, v57
    v_dot2_f32_bf16 v58, v75, s84, v58
    v_dot2_f32_bf16 v59, v75, s86, v59
    s_waitcnt vmcnt(3)
    v_dot2_f32_bf16 v8, v76, s84, v8
    v_dot2_f32_bf16 v9, v76, s86, v9
    v_dot2_f32_bf16 v10, v77, s84, v10
    v_dot2_f32_bf16 v11, v77, s86, v11
    v_dot2_f32_bf16 v24, v78, s84, v24
    v_dot2_f32_bf16 v25, v78, s86, v25
    v_dot2_f32_bf16 v26, v79, s84, v26
    v_dot2_f32_bf16 v27, v79, s86, v27
    s_waitcnt vmcnt(2)
    v_dot2_f32_bf16 v40, v80, s84, v40
    v_dot2_f32_bf16 v41, v80, s86, v41
    v_dot2_f32_bf16 v42, v81, s84, v42
    v_dot2_f32_bf16 v43, v81, s86, v43
    v_dot2_f32_bf16 v56, v82, s84, v56
    v_dot2_f32_bf16 v57, v82, s86, v57
    v_dot2_f32_bf16 v58, v83, s84, v58
    v_dot2_f32_bf16 v59, v83, s86, v59
    s_waitcnt vmcnt(1)
    v_dot2_f32_bf16 v8, v84, s84, v8
    v_dot2_f32_bf16 v9, v84, s86, v9
    v_dot2_f32_bf16 v10, v85, s84, v10
    v_dot2_f32_bf16 v11, v85, s86, v11
    v_dot2_f32_bf16 v24, v86, s84, v24
    v_dot2_f32_bf16 v25, v86, s86, v25
    v_dot2_f32_bf16 v26, v87, s84, v26
    v_dot2_f32_bf16 v27, v87, s86, v27
    s_waitcnt vmcnt(0)
    v_dot2_f32_bf16 v40, v88, s84, v40
    v_dot2_f32_bf16 v41, v88, s86, v41
    v_dot2_f32_bf16 v42, v89, s84, v42
    v_dot2_f32_bf16 v43, v89, s86, v43
    v_dot2_f32_bf16 v56, v90, s84, v56
    v_dot2_f32_bf16 v57, v90, s86, v57
    v_dot2_f32_bf16 v58, v91, s84, v58
    v_dot2_f32_bf16 v59, v91, s86, v59
    s_nop 1
    v_cvt_pk_bf16_f32 v144, v8, v9
    v_cvt_pk_bf16_f32 v145, v10, v11
    buffer_store_dwordx2 v[144:145], v152, s[48:51], 0 offen offset:0
    v_cvt_pk_bf16_f32 v146, v24, v25
    v_cvt_pk_bf16_f32 v147, v26, v27
    buffer_store_dwordx2 v[146:147], v152, s[48:51], 0 offen offset:32
    v_cvt_pk_bf16_f32 v148, v40, v41
    v_cvt_pk_bf16_f32 v149, v42, v43
    buffer_store_dwordx2 v[148:149], v152, s[48:51], 0 offen offset:64
    v_cvt_pk_bf16_f32 v150, v56, v57
    v_cvt_pk_bf16_f32 v151, v58, v59
    buffer_store_dwordx2 v[150:151], v152, s[48:51], 0 offen offset:96
    s_endpgm
K2_T2:
    s_cmp_lg_u32 s6, 2
    s_cbranch_scc1 K2_T3
    s_add_u32 s75, s74, 32768
    v_cvt_pk_bf16_f32 v4, v4, v5
    v_cvt_pk_bf16_f32 v5, v6, v7
    v_cvt_pk_bf16_f32 v6, v20, v21
    v_cvt_pk_bf16_f32 v7, v22, v23
    buffer_store_dwordx4 v[4:7], v132, s[56:59], s75 offen offset:0 sc0 sc1
    v_cvt_pk_bf16_f32 v36, v36, v37
    v_cvt_pk_bf16_f32 v37, v38, v39
    v_cvt_pk_bf16_f32 v38, v52, v53
    v_cvt_pk_bf16_f32 v39, v54, v55
    buffer_store_dwordx4 v[36:39], v132, s[56:59], s75 offen offset:1024 sc0 sc1
    s_add_u32 s75, s74, 98304
    v_cvt_pk_bf16_f32 v8, v8, v9
    v_cvt_pk_bf16_f32 v9, v10, v11
    v_cvt_pk_bf16_f32 v10, v24, v25
    v_cvt_pk_bf16_f32 v11, v26, v27
    buffer_store_dwordx4 v[8:11], v132, s[56:59], s75 offen offset:0 sc0 sc1
    v_cvt_pk_bf16_f32 v40, v40, v41
    v_cvt_pk_bf16_f32 v41, v42, v43
    v_cvt_pk_bf16_f32 v42, v56, v57
    v_cvt_pk_bf16_f32 v43, v58, v59
    buffer_store_dwordx4 v[40:43], v132, s[56:59], s75 offen offset:1024 sc0 sc1
    s_add_u32 s75, s74, 229376
    v_cvt_pk_bf16_f32 v16, v16, v17
    v_cvt_pk_bf16_f32 v17, v18, v19
    v_cvt_pk_bf16_f32 v18, v32, v33
    v_cvt_pk_bf16_f32 v19, v34, v35
    buffer_store_dwordx4 v[16:19], v132, s[56:59], s75 offen offset:0 sc0 sc1
    v_cvt_pk_bf16_f32 v48, v48, v49
    v_cvt_pk_bf16_f32 v49, v50, v51
    v_cvt_pk_bf16_f32 v50, v64, v65
    v_cvt_pk_bf16_f32 v51, v66, v67
    buffer_store_dwordx4 v[48:51], v132, s[56:59], s75 offen offset:1024 sc0 sc1
    s_waitcnt vmcnt(0)
    s_mov_b64 exec, 1
    v_mov_b32 v133, s13
    v_mov_b32 v134, 1
    buffer_atomic_add v134, v133, s[76:79], 0 offen sc1
    buffer_load_dword v135, v133, s[76:79], 0 offen sc0 sc1
    s_mov_b64 exec, -1
    s_mov_b32 s84, 0x3f80
    s_mov_b32 s86, 0x3f800000
    v_dot2_f32_bf16 v12, v144, s84, v12
    v_dot2_f32_bf16 v13, v144, s86, v13
    v_dot2_f32_bf16 v14, v145, s84, v14
    v_dot2_f32_bf16 v15, v145, s86, v15
    v_dot2_f32_bf16 v28, v146, s84, v28
    v_dot2_f32_bf16 v29, v146, s86, v29
    v_dot2_f32_bf16 v30, v147, s84, v30
    v_dot2_f32_bf16 v31, v147, s86, v31
    v_dot2_f32_bf16 v44, v148, s84, v44
    v_dot2_f32_bf16 v45, v148, s86, v45
    v_dot2_f32_bf16 v46, v149, s84, v46
    v_dot2_f32_bf16 v47, v149, s86, v47
    v_dot2_f32_bf16 v60, v150, s84, v60
    v_dot2_f32_bf16 v61, v150, s86, v61
    v_dot2_f32_bf16 v62, v151, s84, v62
    v_dot2_f32_bf16 v63, v151, s86, v63
    s_mov_b64 exec, 1
    s_waitcnt vmcnt(0)
    v_readfirstlane_b32 s73, v135
    s_cmp_ge_u32 s73, 4
    s_cbranch_scc1 K2_PD2
K2_POLL2:
    buffer_load_dword v134, v133, s[76:79], 0 offen sc0 sc1
    s_waitcnt vmcnt(0)
    v_readfirstlane_b32 s73, v134
    s_cmp_ge_u32 s73, 4
    s_cbranch_scc1 K2_PD2
    s_sleep 1
    s_branch K2_POLL2
K2_PD2:
    s_mov_b64 exec, -1
    s_add_u32 s75, s74, 131072
    buffer_load_dwordx4 v[68:71], v132, s[56:59], s75 offen offset:0 sc0 sc1
    buffer_load_dwordx4 v[72:75], v132, s[56:59], s75 offen offset:1024 sc0 sc1
    s_add_u32 s75, s74, 147456
    buffer_load_dwordx4 v[76:79], v132, s[56:59], s75 offen offset:0 sc0 sc1
    buffer_load_dwordx4 v[80:83], v132, s[56:59], s75 offen offset:1024 sc0 sc1
    s_add_u32 s75, s74, 180224
    buffer_load_dwordx4 v[84:87], v132, s[56:59], s75 offen offset:0 sc0 sc1
    buffer_load_dwordx4 v[88:91], v132, s[56:59], s75 offen offset:1024 sc0 sc1
    s_waitcnt vmcnt(5)
    v_dot2_f32_bf16 v12, v68, s84, v12
    v_dot2_f32_bf16 v13, v68, s86, v13
    v_dot2_f32_bf16 v14, v69, s84, v14
    v_dot2_f32_bf16 v15, v69, s86, v15
    v_dot2_f32_bf16 v28, v70, s84, v28
    v_dot2_f32_bf16 v29, v70, s86, v29
    v_dot2_f32_bf16 v30, v71, s84, v30
    v_dot2_f32_bf16 v31, v71, s86, v31
    s_waitcnt vmcnt(4)
    v_dot2_f32_bf16 v44, v72, s84, v44
    v_dot2_f32_bf16 v45, v72, s86, v45
    v_dot2_f32_bf16 v46, v73, s84, v46
    v_dot2_f32_bf16 v47, v73, s86, v47
    v_dot2_f32_bf16 v60, v74, s84, v60
    v_dot2_f32_bf16 v61, v74, s86, v61
    v_dot2_f32_bf16 v62, v75, s84, v62
    v_dot2_f32_bf16 v63, v75, s86, v63
    s_waitcnt vmcnt(3)
    v_dot2_f32_bf16 v12, v76, s84, v12
    v_dot2_f32_bf16 v13, v76, s86, v13
    v_dot2_f32_bf16 v14, v77, s84, v14
    v_dot2_f32_bf16 v15, v77, s86, v15
    v_dot2_f32_bf16 v28, v78, s84, v28
    v_dot2_f32_bf16 v29, v78, s86, v29
    v_dot2_f32_bf16 v30, v79, s84, v30
    v_dot2_f32_bf16 v31, v79, s86, v31
    s_waitcnt vmcnt(2)
    v_dot2_f32_bf16 v44, v80, s84, v44
    v_dot2_f32_bf16 v45, v80, s86, v45
    v_dot2_f32_bf16 v46, v81, s84, v46
    v_dot2_f32_bf16 v47, v81, s86, v47
    v_dot2_f32_bf16 v60, v82, s84, v60
    v_dot2_f32_bf16 v61, v82, s86, v61
    v_dot2_f32_bf16 v62, v83, s84, v62
    v_dot2_f32_bf16 v63, v83, s86, v63
    s_waitcnt vmcnt(1)
    v_dot2_f32_bf16 v12, v84, s84, v12
    v_dot2_f32_bf16 v13, v84, s86, v13
    v_dot2_f32_bf16 v14, v85, s84, v14
    v_dot2_f32_bf16 v15, v85, s86, v15
    v_dot2_f32_bf16 v28, v86, s84, v28
    v_dot2_f32_bf16 v29, v86, s86, v29
    v_dot2_f32_bf16 v30, v87, s84, v30
    v_dot2_f32_bf16 v31, v87, s86, v31
    s_waitcnt vmcnt(0)
    v_dot2_f32_bf16 v44, v88, s84, v44
    v_dot2_f32_bf16 v45, v88, s86, v45
    v_dot2_f32_bf16 v46, v89, s84, v46
    v_dot2_f32_bf16 v47, v89, s86, v47
    v_dot2_f32_bf16 v60, v90, s84, v60
    v_dot2_f32_bf16 v61, v90, s86, v61
    v_dot2_f32_bf16 v62, v91, s84, v62
    v_dot2_f32_bf16 v63, v91, s86, v63
    s_nop 1
    v_cvt_pk_bf16_f32 v144, v12, v13
    v_cvt_pk_bf16_f32 v145, v14, v15
    buffer_store_dwordx2 v[144:145], v152, s[48:51], 0 offen offset:0
    v_cvt_pk_bf16_f32 v146, v28, v29
    v_cvt_pk_bf16_f32 v147, v30, v31
    buffer_store_dwordx2 v[146:147], v152, s[48:51], 0 offen offset:32
    v_cvt_pk_bf16_f32 v148, v44, v45
    v_cvt_pk_bf16_f32 v149, v46, v47
    buffer_store_dwordx2 v[148:149], v152, s[48:51], 0 offen offset:64
    v_cvt_pk_bf16_f32 v150, v60, v61
    v_cvt_pk_bf16_f32 v151, v62, v63
    buffer_store_dwordx2 v[150:151], v152, s[48:51], 0 offen offset:96
    s_endpgm
K2_T3:
    s_add_u32 s75, s74, 49152
    v_cvt_pk_bf16_f32 v4, v4, v5
    v_cvt_pk_bf16_f32 v5, v6, v7
    v_cvt_pk_bf16_f32 v6, v20, v21
    v_cvt_pk_bf16_f32 v7, v22, v23
    buffer_store_dwordx4 v[4:7], v132, s[56:59], s75 offen offset:0 sc0 sc1
    v_cvt_pk_bf16_f32 v36, v36, v37
    v_cvt_pk_bf16_f32 v37, v38, v39
    v_cvt_pk_bf16_f32 v38, v52, v53
    v_cvt_pk_bf16_f32 v39, v54, v55
    buffer_store_dwordx4 v[36:39], v132, s[56:59], s75 offen offset:1024 sc0 sc1
    s_add_u32 s75, s74, 114688
    v_cvt_pk_bf16_f32 v8, v8, v9
    v_cvt_pk_bf16_f32 v9, v10, v11
    v_cvt_pk_bf16_f32 v10, v24, v25
    v_cvt_pk_bf16_f32 v11, v26, v27
    buffer_store_dwordx4 v[8:11], v132, s[56:59], s75 offen offset:0 sc0 sc1
    v_cvt_pk_bf16_f32 v40, v40, v41
    v_cvt_pk_bf16_f32 v41, v42, v43
    v_cvt_pk_bf16_f32 v42, v56, v57
    v_cvt_pk_bf16_f32 v43, v58, v59
    buffer_store_dwordx4 v[40:43], v132, s[56:59], s75 offen offset:1024 sc0 sc1
    s_add_u32 s75, s74, 180224
    v_cvt_pk_bf16_f32 v12, v12, v13
    v_cvt_pk_bf16_f32 v13, v14, v15
    v_cvt_pk_bf16_f32 v14, v28, v29
    v_cvt_pk_bf16_f32 v15, v30, v31
    buffer_store_dwordx4 v[12:15], v132, s[56:59], s75 offen offset:0 sc0 sc1
    v_cvt_pk_bf16_f32 v44, v44, v45
    v_cvt_pk_bf16_f32 v45, v46, v47
    v_cvt_pk_bf16_f32 v46, v60, v61
    v_cvt_pk_bf16_f32 v47, v62, v63
    buffer_store_dwordx4 v[44:47], v132, s[56:59], s75 offen offset:1024 sc0 sc1
    s_waitcnt vmcnt(0)
    s_mov_b64 exec, 1
    v_mov_b32 v133, s13
    v_mov_b32 v134, 1
    buffer_atomic_add v134, v133, s[76:79], 0 offen sc1
    buffer_load_dword v135, v133, s[76:79], 0 offen sc0 sc1
    s_mov_b64 exec, -1
    s_mov_b32 s84, 0x3f80
    s_mov_b32 s86, 0x3f800000
    v_dot2_f32_bf16 v16, v144, s84, v16
    v_dot2_f32_bf16 v17, v144, s86, v17
    v_dot2_f32_bf16 v18, v145, s84, v18
    v_dot2_f32_bf16 v19, v145, s86, v19
    v_dot2_f32_bf16 v32, v146, s84, v32
    v_dot2_f32_bf16 v33, v146, s86, v33
    v_dot2_f32_bf16 v34, v147, s84, v34
    v_dot2_f32_bf16 v35, v147, s86, v35
    v_dot2_f32_bf16 v48, v148, s84, v48
    v_dot2_f32_bf16 v49, v148, s86, v49
    v_dot2_f32_bf16 v50, v149, s84, v50
    v_dot2_f32_bf16 v51, v149, s86, v51
    v_dot2_f32_bf16 v64, v150, s84, v64
    v_dot2_f32_bf16 v65, v150, s86, v65
    v_dot2_f32_bf16 v66, v151, s84, v66
    v_dot2_f32_bf16 v67, v151, s86, v67
    s_mov_b64 exec, 1
    s_waitcnt vmcnt(0)
    v_readfirstlane_b32 s73, v135
    s_cmp_ge_u32 s73, 4
    s_cbranch_scc1 K2_PD3
K2_POLL3:
    buffer_load_dword v134, v133, s[76:79], 0 offen sc0 sc1
    s_waitcnt vmcnt(0)
    v_readfirstlane_b32 s73, v134
    s_cmp_ge_u32 s73, 4
    s_cbranch_scc1 K2_PD3
    s_sleep 1
    s_branch K2_POLL3
K2_PD3:
    s_mov_b64 exec, -1
    s_add_u32 s75, s74, 196608
    buffer_load_dwordx4 v[68:71], v132, s[56:59], s75 offen offset:0 sc0 sc1
    buffer_load_dwordx4 v[72:75], v132, s[56:59], s75 offen offset:1024 sc0 sc1
    s_add_u32 s75, s74, 212992
    buffer_load_dwordx4 v[76:79], v132, s[56:59], s75 offen offset:0 sc0 sc1
    buffer_load_dwordx4 v[80:83], v132, s[56:59], s75 offen offset:1024 sc0 sc1
    s_add_u32 s75, s74, 229376
    buffer_load_dwordx4 v[84:87], v132, s[56:59], s75 offen offset:0 sc0 sc1
    buffer_load_dwordx4 v[88:91], v132, s[56:59], s75 offen offset:1024 sc0 sc1
    s_waitcnt vmcnt(5)
    v_dot2_f32_bf16 v16, v68, s84, v16
    v_dot2_f32_bf16 v17, v68, s86, v17
    v_dot2_f32_bf16 v18, v69, s84, v18
    v_dot2_f32_bf16 v19, v69, s86, v19
    v_dot2_f32_bf16 v32, v70, s84, v32
    v_dot2_f32_bf16 v33, v70, s86, v33
    v_dot2_f32_bf16 v34, v71, s84, v34
    v_dot2_f32_bf16 v35, v71, s86, v35
    s_waitcnt vmcnt(4)
    v_dot2_f32_bf16 v48, v72, s84, v48
    v_dot2_f32_bf16 v49, v72, s86, v49
    v_dot2_f32_bf16 v50, v73, s84, v50
    v_dot2_f32_bf16 v51, v73, s86, v51
    v_dot2_f32_bf16 v64, v74, s84, v64
    v_dot2_f32_bf16 v65, v74, s86, v65
    v_dot2_f32_bf16 v66, v75, s84, v66
    v_dot2_f32_bf16 v67, v75, s86, v67
    s_waitcnt vmcnt(3)
    v_dot2_f32_bf16 v16, v76, s84, v16
    v_dot2_f32_bf16 v17, v76, s86, v17
    v_dot2_f32_bf16 v18, v77, s84, v18
    v_dot2_f32_bf16 v19, v77, s86, v19
    v_dot2_f32_bf16 v32, v78, s84, v32
    v_dot2_f32_bf16 v33, v78, s86, v33
    v_dot2_f32_bf16 v34, v79, s84, v34
    v_dot2_f32_bf16 v35, v79, s86, v35
    s_waitcnt vmcnt(2)
    v_dot2_f32_bf16 v48, v80, s84, v48
    v_dot2_f32_bf16 v49, v80, s86, v49
    v_dot2_f32_bf16 v50, v81, s84, v50
    v_dot2_f32_bf16 v51, v81, s86, v51
    v_dot2_f32_bf16 v64, v82, s84, v64
    v_dot2_f32_bf16 v65, v82, s86, v65
    v_dot2_f32_bf16 v66, v83, s84, v66
    v_dot2_f32_bf16 v67, v83, s86, v67
    s_waitcnt vmcnt(1)
    v_dot2_f32_bf16 v16, v84, s84, v16
    v_dot2_f32_bf16 v17, v84, s86, v17
    v_dot2_f32_bf16 v18, v85, s84, v18
    v_dot2_f32_bf16 v19, v85, s86, v19
    v_dot2_f32_bf16 v32, v86, s84, v32
    v_dot2_f32_bf16 v33, v86, s86, v33
    v_dot2_f32_bf16 v34, v87, s84, v34
    v_dot2_f32_bf16 v35, v87, s86, v35
    s_waitcnt vmcnt(0)
    v_dot2_f32_bf16 v48, v88, s84, v48
    v_dot2_f32_bf16 v49, v88, s86, v49
    v_dot2_f32_bf16 v50, v89, s84, v50
    v_dot2_f32_bf16 v51, v89, s86, v51
    v_dot2_f32_bf16 v64, v90, s84, v64
    v_dot2_f32_bf16 v65, v90, s86, v65
    v_dot2_f32_bf16 v66, v91, s84, v66
    v_dot2_f32_bf16 v67, v91, s86, v67
    s_nop 1
    v_cvt_pk_bf16_f32 v144, v16, v17
    v_cvt_pk_bf16_f32 v145, v18, v19
    buffer_store_dwordx2 v[144:145], v152, s[48:51], 0 offen offset:0
    v_cvt_pk_bf16_f32 v146, v32, v33
    v_cvt_pk_bf16_f32 v147, v34, v35
    buffer_store_dwordx2 v[146:147], v152, s[48:51], 0 offen offset:32
    v_cvt_pk_bf16_f32 v148, v48, v49
    v_cvt_pk_bf16_f32 v149, v50, v51
    buffer_store_dwordx2 v[148:149], v152, s[48:51], 0 offen offset:64
    v_cvt_pk_bf16_f32 v150, v64, v65
    v_cvt_pk_bf16_f32 v151, v66, v67
    buffer_store_dwordx2 v[150:151], v152, s[48:51], 0 offen offset:96
    s_endpgm
K2_END:
    s_endpgm
CODE_END:
.section .rodata,"a"
.p2align 6
.amdhsa_kernel fused_kernel
  .amdhsa_next_free_vgpr 256
  .amdhsa_next_free_sgpr 102
  .amdhsa_accum_offset 256
  .amdhsa_group_segment_fixed_size 0
  .amdhsa_kernarg_size 88
  .amdhsa_user_sgpr_count 2
  .amdhsa_user_sgpr_kernarg_segment_ptr 1
  .amdhsa_system_sgpr_workgroup_id_x 1
.end_amdhsa_kernel
```
